```python
import torch

def _softmax(x, axis=-1):
    return torch.softmax(x, dim=axis)
def _gelu(x):
    return torch.nn.functional.gelu(x, approximate="tanh")
def _silu(x):
    return torch.nn.functional.silu(x)
def _sigmoid(x):
    return torch.sigmoid(x)
def _layernorm(x, axis=-1, eps=1e-5):
    m = x.mean(dim=axis, keepdim=True)
    v = x.var(dim=axis, keepdim=True, unbiased=False)
    return (x - m) / torch.sqrt(v + eps)
def _scatter_add(tgt, idx, src, axis=0):
    return tgt.clone().index_add_(axis, idx, src)
def _segment_sum(src, seg, n):
    out = torch.zeros((n,) + src.shape[1:], dtype=src.dtype)
    return out.index_add_(0, seg, src)
def _pad(x, pw):
    flat = tuple(v for pair in reversed(pw) for v in pair)
    return torch.nn.functional.pad(x, flat)

kernel_name = 'sequential_preLN__sliding_block_cached__moe_arch_mod__decode'

def setup_inputs():

    _w = (lambda a: (lambda t: t.to(torch.bfloat16) if t.is_floating_point() else t)(torch.as_tensor(a)))
    def _A_setup():
        B, Sq, D = 2, 1, 512
        Hq, Hkv, Sk, Dh = 32, 32, 16384, 128
        assert Hq % Hkv == 0, (Hq, Hkv)
        return {
            "x": _w((lambda *s: torch.randn(*s, dtype=torch.bfloat16) * 0.05)(B, Sq, D)),
            "k_cache": _w((lambda *s: torch.randn(*s, dtype=torch.bfloat16) * 3.2)(B, Hkv, Sk, Dh)),
            "v_cache": _w((lambda *s: torch.randn(*s, dtype=torch.bfloat16) * 0.4)(B, Hkv, Sk, Dh)),
            "wq": _w((lambda *s: torch.randn(*s, dtype=torch.bfloat16) * 3.2)(D, Hq * Dh) * (D ** -0.5)),
            "wo": _w((lambda *s: torch.randn(*s, dtype=torch.bfloat16) * 0.4)(Hq * Dh, D) * ((Hq * Dh) ** -0.5)),
        }
    _A_in = _A_setup()

    def _B_setup():
        B, S, D, F, C = 2, 1, 512, 1376, 1
        return {
            "x": _w((lambda *s: torch.randn(*s, dtype=torch.bfloat16) * 0.05)(B, S, D)),
            "w_r": _w((lambda *s: torch.randn(*s, dtype=torch.bfloat16) * 3.2)(D)),
            "w_gate": _w((lambda *s: torch.randn(*s, dtype=torch.bfloat16) * 0.1)(D, F)),
            "w_up": _w((lambda *s: torch.randn(*s, dtype=torch.bfloat16) * 0.1)(D, F)),
            "w_down": _w((lambda *s: torch.randn(*s, dtype=torch.bfloat16) * 0.1)(F, D)),
        }
    _B_in = _B_setup()

    return {
        "A_x": _A_in["x"],
        "A_k_cache": _A_in["k_cache"],
        "A_v_cache": _A_in["v_cache"],
        "A_wq": _A_in["wq"],
        "A_wo": _A_in["wo"],
        "B_x": _B_in["x"],
        "B_w_r": _B_in["w_r"],
        "B_w_gate": _B_in["w_gate"],
        "B_w_up": _B_in["w_up"],
        "B_w_down": _B_in["w_down"],
    }

def reference(A_x, A_k_cache, A_v_cache, A_wq, A_wo, B_x, B_w_r, B_w_gate, B_w_up, B_w_down):
    def _A_ref(x, k_cache, v_cache, wq, wo):
        B, Sq, D = x.shape
        Hq, Dh = 32, 128
        Hkv, Sk = k_cache.shape[1], k_cache.shape[2]
        W = min(4096, max(256, Sk // 4))
        rep = Hq // Hkv
        q = (lambda x, *d: x.permute(*d))((x @ wq).reshape(B, Sq, Hq, Dh), 0, 2, 1, 3)
        k = (lambda x, n, axis: torch.repeat_interleave(x, n, dim=axis))(k_cache[:, :, Sk - W:, :], rep, axis=1)
        v = (lambda x, n, axis: torch.repeat_interleave(x, n, dim=axis))(v_cache[:, :, Sk - W:, :], rep, axis=1)
        scores = torch.einsum("bhqd,bhkd->bhqk", q, k) * (Dh ** -0.5)
        p = _softmax(scores, axis=-1)
        o = torch.einsum("bhqk,bhkd->bhqd", p, v)
        return (lambda x, *d: x.permute(*d))(o, 0, 2, 1, 3).reshape(B, Sq, Hq * Dh) @ wo

    def _B_ref(x, w_r, w_gate, w_up, w_down):
        B, S, D = x.shape
        C = 1
        r = x @ w_r
        idx = torch.argsort(-r, axis=-1)[:, :C]
        idx_e = (lambda x, n, axis: torch.repeat_interleave(x, n, dim=axis))(idx.reshape(B, C, 1), D, axis=2)
        x_sel = (lambda x, i, axis: torch.take_along_dim(x, i, dim=axis))(x, idx_e, axis=1)
        g = _silu(x_sel @ w_gate)
        u = x_sel @ w_up
        y = (g * u) @ w_down
        r_sel = _sigmoid((lambda x, i, axis: torch.take_along_dim(x, i, dim=axis))(r, idx, axis=1))
        y = y * r_sel.reshape(B, C, 1)
        b_off = (torch.arange(B) * S).reshape(B, 1)
        flat_idx = (idx + b_off).reshape(B * C)
        zero = (x * 0.0).reshape(B * S, D)
        upd = _scatter_add(zero, flat_idx, y.reshape(B * C, D), axis=0)
        return x + upd.reshape(B, S, D)

    x = A_x
    h = x + _A_ref(_layernorm(x, axis=-1), A_k_cache, A_v_cache, A_wq, A_wo)
    h2 = h + _B_ref(_layernorm(h, axis=-1), B_w_r, B_w_gate, B_w_up, B_w_down)
    return h2
```

```asm
; @launch grid=(256,1,1) block=(576,1,1) lds=118784
.amdgcn_target "amdgcn-amd-amdhsa--gfx950"
.text
.globl sequential_preLN__sliding_block_cached__moe_arch_mod__decode_kernel
.p2align 8
.type sequential_preLN__sliding_block_cached__moe_arch_mod__decode_kernel,@function
sequential_preLN__sliding_block_cached__moe_arch_mod__decode_kernel:
L_start:
    s_cmp_ge_u32 s2, 256
    s_cbranch_scc1 L_end
    s_load_dwordx16 s[4:19], s[0:1], 0
    s_load_dwordx8 s[20:27], s[0:1], 64
    s_load_dwordx2 s[28:29], s[0:1], 96
    s_memrealtime s[70:71]
    v_and_b32 v1, 63, v0
    v_lshrrev_b32 v40, 6, v0
    s_getpc_b64 s[48:49]
L_pc:
    s_sub_u32 s48, s48, L_pc-L_start
    s_subb_u32 s49, s49, 0
    s_mov_b32 s50, L_codeend-L_start
    s_mov_b32 s51, 0x20000
    s_lshr_b32 s100, s2, 3
    s_lshl_b32 s100, s100, 10
    v_lshlrev_b32 v45, 7, v40
    buffer_load_dword v167, v45, s[48:51], s100 offen
    v_readfirstlane_b32 s75, v40
    v_lshlrev_b32 v2, 4, v1
    s_and_b32 s72, s2, 31
    s_bfe_u32 s73, s2, 0x10005
    s_lshr_b32 s74, s2, 6
    s_lshr_b32 s78, s2, 5
    v_lshrrev_b32 v41, 4, v1
    v_and_b32 v42, 15, v1
    s_cmp_eq_u32 s75, 8
    s_cbranch_scc1 L_svc
    s_mul_i32 s101, s74, 68
    s_add_u32 s101, s101, -16
    s_cmp_eq_u32 s74, 0
    s_cselect_b32 s101, 0, s101
    s_mov_b32 s34, 68
    s_cselect_b32 s34, 52, s34
    s_lshl_b32 s38, s74, 6
    s_and_b32 s100, s2, 63
    s_cmp_lt_u32 s100, 43
    s_cselect_b32 s101, s101, s38
    s_cselect_b32 s34, s34, 64
    s_mul_i32 s38, s100, 3
    s_add_u32 s101, s101, s38
    s_add_u32 s101, s101, s75
    s_lshl_b32 s41, s101, 12
    s_sub_u32 s69, s34, s75
    s_lshl_b32 s69, s69, 12
    s_lshl_b32 s100, s100, 22
    s_add_u32 s100, s100, 0x300000
    s_mov_b32 s34, 0x100000
    s_mov_b32 s35, 0x20000
    s_mov_b32 s38, 0x100000
    s_mov_b32 s39, 0x20000
    s_and_b32 s40, s41, 0xfffff
    s_waitcnt lgkmcnt(0)
    s_add_u32 s32, s6, s100
    s_addc_u32 s33, s7, 0
    s_add_u32 s36, s8, s100
    s_addc_u32 s37, s9, 0
    s_mov_b32 s58, 0x100000
    s_mov_b32 s59, 0x20000
    s_mov_b64 s[56:57], s[32:33]
    buffer_load_dwordx4 v[80:83], v2, s[32:35], s40 offen offset:0 nt
    buffer_load_dwordx4 v[84:87], v2, s[32:35], s40 offen offset:1024 nt
    buffer_load_dwordx4 v[88:91], v2, s[32:35], s40 offen offset:2048 nt
    s_barrier
    s_mov_b32 s30, 0x3fb8aa3b
    s_mov_b32 s31, 0x05040100
    s_mov_b32 s3, 0x07060302
    s_mov_b32 s52, s28
    s_mov_b32 s53, s29
    s_mov_b32 s54, 4194304
    s_mov_b32 s55, 0x20000
    v_lshlrev_b32 v44, 2, v0
    v_add_u32 v44, 4096, v44
    v_and_b32 v26, 1, v1
    v_lshlrev_b32 v26, 4, v26
    v_mov_b32 v27, 0xffff
    v_lshlrev_b32 v27, v26, v27
    v_bfe_u32 v26, v1, 1, 2
    v_cmp_eq_u32 vcc, 0, v26
    s_nop 1
    v_cndmask_b32 v5, 0, v27, vcc
    v_cmp_eq_u32 vcc, 1, v26
    s_nop 1
    v_cndmask_b32 v6, 0, v27, vcc
    v_cmp_eq_u32 vcc, 2, v26
    s_nop 1
    v_cndmask_b32 v7, 0, v27, vcc
    v_cmp_eq_u32 vcc, 3, v26
    s_nop 1
    v_cndmask_b32 v8, 0, v27, vcc
    v_lshlrev_b32 v43, 3, v1
    v_lshlrev_b32 v27, 4, v42
    v_bfe_u32 v25, v1, 3, 1
    v_lshlrev_b32 v3, 12, v25
    v_lshl_add_u32 v3, v41, 10, v3
    v_lshl_add_u32 v3, v40, 7, v3
    v_and_b32 v25, 7, v1
    v_lshl_add_u32 v3, v25, 4, v3
    s_lshl_b32 s100, s72, 17
    s_add_u32 s44, s12, s100
    s_addc_u32 s45, s13, 0
    s_mov_b32 s46, 0x20000
    s_mov_b32 s47, 0x20000
    s_waitcnt vmcnt(2)
    buffer_load_dwordx4 v[92:95], v2, s[32:35], s40 offen offset:3072 nt
    s_waitcnt vmcnt(2)
    s_add_u32 s76, s41, 32768
    s_and_b32 s76, s76, 0xfffff
    buffer_load_dwordx4 v[96:99], v2, s[32:35], s76 offen offset:0 nt
    s_waitcnt vmcnt(2)
    buffer_load_dwordx4 v[112:115], v2, s[36:39], s40 offen offset:0 nt
    s_waitcnt vmcnt(2)
    s_add_u32 s76, s41, 32768
    s_and_b32 s76, s76, 0xfffff
    buffer_load_dwordx4 v[100:103], v2, s[32:35], s76 offen offset:1024 nt
    s_waitcnt vmcnt(2)
    buffer_load_dwordx4 v[116:119], v2, s[36:39], s40 offen offset:1024 nt
    s_waitcnt vmcnt(2)
    s_add_u32 s76, s41, 32768
    s_and_b32 s76, s76, 0xfffff
    buffer_load_dwordx4 v[104:107], v2, s[32:35], s76 offen offset:2048 nt
    s_waitcnt vmcnt(2)
    buffer_load_dwordx4 v[120:123], v2, s[36:39], s40 offen offset:2048 nt
    s_waitcnt vmcnt(2)
    s_add_u32 s76, s41, 32768
    s_and_b32 s76, s76, 0xfffff
    buffer_load_dwordx4 v[108:111], v2, s[32:35], s76 offen offset:3072 nt
    s_waitcnt vmcnt(2)
    buffer_load_dwordx4 v[124:127], v2, s[36:39], s40 offen offset:3072 nt
    s_waitcnt vmcnt(2)
    s_add_u32 s76, s41, 65536
    s_and_b32 s76, s76, 0xfffff
    buffer_load_dwordx4 v[48:51], v2, s[32:35], s76 offen offset:0 nt
    s_waitcnt vmcnt(2)
    s_add_u32 s76, s41, 32768
    s_and_b32 s76, s76, 0xfffff
    buffer_load_dwordx4 v[64:67], v2, s[36:39], s76 offen offset:0 nt
    s_waitcnt vmcnt(2)
    s_add_u32 s76, s41, 65536
    s_and_b32 s76, s76, 0xfffff
    buffer_load_dwordx4 v[52:55], v2, s[32:35], s76 offen offset:1024 nt
    s_waitcnt vmcnt(2)
    s_add_u32 s76, s41, 32768
    s_and_b32 s76, s76, 0xfffff
    buffer_load_dwordx4 v[68:71], v2, s[36:39], s76 offen offset:1024 nt
    s_waitcnt vmcnt(2)
    s_add_u32 s76, s41, 65536
    s_and_b32 s76, s76, 0xfffff
    buffer_load_dwordx4 v[56:59], v2, s[32:35], s76 offen offset:2048 nt
    v_mov_b32 v26, 0
    s_mov_b32 s77, 3200000
L_qwait:
    ds_read_b32 v25, v26 offset:6528
    ds_read_b128 v[10:13], v27 offset:6656
    s_sub_u32 s77, s77, 1
    s_cbranch_scc1 L_end
    s_waitcnt lgkmcnt(0)
    v_readfirstlane_b32 s100, v25
    s_cmp_eq_u32 s100, 0
    s_cbranch_scc1 L_qwait
    v_dot2_f32_bf16 v19, v80, v10, 0
    v_dot2_f32_bf16 v19, v81, v11, v19
    v_dot2_f32_bf16 v19, v82, v12, v19
    v_dot2_f32_bf16 v19, v83, v13, v19
    v_dot2_f32_bf16 v20, v84, v10, 0
    v_dot2_f32_bf16 v20, v85, v11, v20
    v_dot2_f32_bf16 v20, v86, v12, v20
    v_dot2_f32_bf16 v20, v87, v13, v20
    v_add_f32_dpp v23, v19, v19 row_ror:8 row_mask:0xf bank_mask:0x3
    s_nop 1
    v_add_f32_dpp v23, v20, v20 row_ror:8 row_mask:0xf bank_mask:0xc
    v_dot2_f32_bf16 v21, v88, v10, 0
    v_dot2_f32_bf16 v21, v89, v11, v21
    v_dot2_f32_bf16 v21, v90, v12, v21
    v_dot2_f32_bf16 v21, v91, v13, v21
    v_dot2_f32_bf16 v22, v92, v10, 0
    v_dot2_f32_bf16 v22, v93, v11, v22
    v_dot2_f32_bf16 v22, v94, v12, v22
    v_dot2_f32_bf16 v22, v95, v13, v22
    s_add_u32 s76, s41, 32768
    s_and_b32 s76, s76, 0xfffff
    buffer_load_dwordx4 v[72:75], v2, s[36:39], s76 offen offset:2048 nt
    v_add_f32_dpp v18, v23, v23 row_half_mirror row_mask:0xf bank_mask:0x5
    v_add_f32_dpp v24, v21, v21 row_ror:8 row_mask:0xf bank_mask:0x3
    s_nop 1
    v_add_f32_dpp v24, v22, v22 row_ror:8 row_mask:0xf bank_mask:0xc
    s_nop 1
    v_add_f32_dpp v18, v24, v24 row_half_mirror row_mask:0xf bank_mask:0xa
    s_nop 1
    v_add_f32_dpp v18, v18, v18 quad_perm:[1,0,3,2] row_mask:0xf bank_mask:0xf
    s_nop 1
    v_add_f32_dpp v18, v18, v18 quad_perm:[2,3,0,1] row_mask:0xf bank_mask:0xf
    v_cvt_pk_bf16_f32 v18, v18, v18
    v_and_b32 v18, 0xffff0000, v18
    v_mul_f32 v18, 0x3db504f3, v18
    v_cvt_pk_bf16_f32 v18, v18, v18
    v_and_b32 v18, 0xffff0000, v18
    s_nop 1
    v_max_f32_dpp v26, v18, v18 row_ror:4 row_mask:0xf bank_mask:0xf
    s_nop 1
    v_max_f32_dpp v26, v26, v26 row_ror:8 row_mask:0xf bank_mask:0xf
    s_nop 1
    v_max_f32_dpp v26, v26, v26 row_bcast:15 row_mask:0xa bank_mask:0xf
    s_nop 1
    v_max_f32_dpp v26, v26, v26 row_bcast:31 row_mask:0xc bank_mask:0xf
    s_nop 0
    v_readlane_b32 s100, v26, 63
    s_nop 1
    v_mov_b32 v26, s100
    v_mul_f32 v27, s30, v26
    v_fma_f32 v25, v18, s30, -v27
    v_exp_f32 v25, v25
    s_nop 0
    v_mov_b32 v15, v25
    v_cvt_pk_bf16_f32 v16, v25, v25
    v_mov_b32 v14, v26
    v_dot2_f32_bf16 v19, v96, v10, 0
    v_dot2_f32_bf16 v19, v97, v11, v19
    v_dot2_f32_bf16 v19, v98, v12, v19
    v_dot2_f32_bf16 v19, v99, v13, v19
    v_and_b32_dpp v32, v16, v5 row_newbcast:0 row_mask:0xf bank_mask:0xf
    v_and_b32_dpp v33, v16, v6 row_newbcast:0 row_mask:0xf bank_mask:0xf
    v_and_b32_dpp v34, v16, v7 row_newbcast:0 row_mask:0xf bank_mask:0xf
    v_and_b32_dpp v35, v16, v8 row_newbcast:0 row_mask:0xf bank_mask:0xf
    s_nop 1
    v_mfma_f32_16x16x32_bf16 v[28:31], v[32:35], v[112:115], 0
    v_dot2_f32_bf16 v20, v100, v10, 0
    v_dot2_f32_bf16 v20, v101, v11, v20
    v_dot2_f32_bf16 v20, v102, v12, v20
    v_dot2_f32_bf16 v20, v103, v13, v20
    v_add_f32_dpp v23, v19, v19 row_ror:8 row_mask:0xf bank_mask:0x3
    s_nop 1
    v_add_f32_dpp v23, v20, v20 row_ror:8 row_mask:0xf bank_mask:0xc
    v_and_b32_dpp v36, v16, v5 row_newbcast:8 row_mask:0xf bank_mask:0xf
    v_and_b32_dpp v37, v16, v6 row_newbcast:8 row_mask:0xf bank_mask:0xf
    v_and_b32_dpp v38, v16, v7 row_newbcast:8 row_mask:0xf bank_mask:0xf
    v_and_b32_dpp v39, v16, v8 row_newbcast:8 row_mask:0xf bank_mask:0xf
    s_nop 1
    v_mfma_f32_16x16x32_bf16 v[28:31], v[36:39], v[116:119], v[28:31]
    s_add_u32 s76, s41, 65536
    s_and_b32 s76, s76, 0xfffff
    buffer_load_dwordx4 v[60:63], v2, s[32:35], s76 offen offset:3072 nt
    v_dot2_f32_bf16 v21, v104, v10, 0
    v_dot2_f32_bf16 v21, v105, v11, v21
    v_dot2_f32_bf16 v21, v106, v12, v21
    v_dot2_f32_bf16 v21, v107, v13, v21
    v_and_b32_dpp v32, v16, v5 row_newbcast:4 row_mask:0xf bank_mask:0xf
    v_and_b32_dpp v33, v16, v6 row_newbcast:4 row_mask:0xf bank_mask:0xf
    v_and_b32_dpp v34, v16, v7 row_newbcast:4 row_mask:0xf bank_mask:0xf
    v_and_b32_dpp v35, v16, v8 row_newbcast:4 row_mask:0xf bank_mask:0xf
    s_nop 1
    v_mfma_f32_16x16x32_bf16 v[28:31], v[32:35], v[120:123], v[28:31]
    v_dot2_f32_bf16 v22, v108, v10, 0
    v_dot2_f32_bf16 v22, v109, v11, v22
    v_dot2_f32_bf16 v22, v110, v12, v22
    v_dot2_f32_bf16 v22, v111, v13, v22
    v_and_b32_dpp v36, v16, v5 row_newbcast:12 row_mask:0xf bank_mask:0xf
    v_and_b32_dpp v37, v16, v6 row_newbcast:12 row_mask:0xf bank_mask:0xf
    v_and_b32_dpp v38, v16, v7 row_newbcast:12 row_mask:0xf bank_mask:0xf
    v_and_b32_dpp v39, v16, v8 row_newbcast:12 row_mask:0xf bank_mask:0xf
    v_add_f32_dpp v18, v23, v23 row_half_mirror row_mask:0xf bank_mask:0x5
    v_add_f32_dpp v24, v21, v21 row_ror:8 row_mask:0xf bank_mask:0x3
    s_nop 1
    v_add_f32_dpp v24, v22, v22 row_ror:8 row_mask:0xf bank_mask:0xc
    s_nop 1
    v_add_f32_dpp v18, v24, v24 row_half_mirror row_mask:0xf bank_mask:0xa
    s_nop 1
    v_add_f32_dpp v18, v18, v18 quad_perm:[1,0,3,2] row_mask:0xf bank_mask:0xf
    s_nop 1
    v_add_f32_dpp v18, v18, v18 quad_perm:[2,3,0,1] row_mask:0xf bank_mask:0xf
    v_cvt_pk_bf16_f32 v18, v18, v18
    v_and_b32 v18, 0xffff0000, v18
    v_mul_f32 v18, 0x3db504f3, v18
    v_cvt_pk_bf16_f32 v18, v18, v18
    v_and_b32 v18, 0xffff0000, v18
    s_nop 1
    v_max_f32_dpp v26, v18, v18 row_ror:4 row_mask:0xf bank_mask:0xf
    s_nop 1
    v_max_f32_dpp v26, v26, v26 row_ror:8 row_mask:0xf bank_mask:0xf
    s_nop 1
    v_max_f32_dpp v26, v26, v26 row_bcast:15 row_mask:0xa bank_mask:0xf
    s_nop 1
    v_max_f32_dpp v26, v26, v26 row_bcast:31 row_mask:0xc bank_mask:0xf
    s_nop 0
    v_readlane_b32 s100, v26, 63
    s_nop 1
    v_max_f32 v26, s100, v14
    v_mul_f32 v27, s30, v26
    v_fma_f32 v25, v18, s30, -v27
    v_exp_f32 v25, v25
    v_fma_f32 v17, v14, s30, -v27
    v_exp_f32 v17, v17
    s_nop 0
    v_fma_f32 v15, v15, v17, v25
    v_cvt_pk_bf16_f32 v16, v25, v25
    v_mov_b32 v14, v26
    v_mfma_f32_16x16x32_bf16 v[28:31], v[36:39], v[124:127], v[28:31]
    s_add_u32 s76, s41, 32768
    s_and_b32 s76, s76, 0xfffff
    buffer_load_dwordx4 v[76:79], v2, s[36:39], s76 offen offset:3072 nt
    v_dot2_f32_bf16 v19, v48, v10, 0
    v_dot2_f32_bf16 v19, v49, v11, v19
    v_dot2_f32_bf16 v19, v50, v12, v19
    v_dot2_f32_bf16 v19, v51, v13, v19
    buffer_load_dwordx4 v[80:83], v3, s[44:47], 0 offen nt
    v_and_b32_dpp v32, v16, v5 row_newbcast:0 row_mask:0xf bank_mask:0xf
    v_and_b32_dpp v33, v16, v6 row_newbcast:0 row_mask:0xf bank_mask:0xf
    v_and_b32_dpp v34, v16, v7 row_newbcast:0 row_mask:0xf bank_mask:0xf
    v_and_b32_dpp v35, v16, v8 row_newbcast:0 row_mask:0xf bank_mask:0xf
    v_mul_f32 v28, v28, v17
    v_mul_f32 v29, v29, v17
    v_mul_f32 v30, v30, v17
    v_mul_f32 v31, v31, v17
    s_nop 1
    v_mfma_f32_16x16x32_bf16 v[28:31], v[32:35], v[64:67], v[28:31]
    s_mov_b32 s76, 8192
    buffer_load_dwordx4 v[84:87], v3, s[44:47], s76 offen nt
    s_waitcnt vmcnt(7)
    v_dot2_f32_bf16 v20, v52, v10, 0
    v_dot2_f32_bf16 v20, v53, v11, v20
    v_dot2_f32_bf16 v20, v54, v12, v20
    v_dot2_f32_bf16 v20, v55, v13, v20
    v_add_f32_dpp v23, v19, v19 row_ror:8 row_mask:0xf bank_mask:0x3
    s_nop 1
    v_add_f32_dpp v23, v20, v20 row_ror:8 row_mask:0xf bank_mask:0xc
    v_and_b32_dpp v36, v16, v5 row_newbcast:8 row_mask:0xf bank_mask:0xf
    v_and_b32_dpp v37, v16, v6 row_newbcast:8 row_mask:0xf bank_mask:0xf
    v_and_b32_dpp v38, v16, v7 row_newbcast:8 row_mask:0xf bank_mask:0xf
    v_and_b32_dpp v39, v16, v8 row_newbcast:8 row_mask:0xf bank_mask:0xf
    s_waitcnt vmcnt(6)
    s_nop 0
    v_mfma_f32_16x16x32_bf16 v[28:31], v[36:39], v[68:71], v[28:31]
    s_mov_b32 s76, 16384
    buffer_load_dwordx4 v[88:91], v3, s[44:47], s76 offen nt
    s_waitcnt vmcnt(6)
    v_dot2_f32_bf16 v21, v56, v10, 0
    v_dot2_f32_bf16 v21, v57, v11, v21
    v_dot2_f32_bf16 v21, v58, v12, v21
    v_dot2_f32_bf16 v21, v59, v13, v21
    s_add_u32 s76, s41, 98304
    s_and_b32 s76, s76, 0xfffff
    buffer_load_dwordx4 v[48:51], v2, s[32:35], s76 offen offset:0 nt
    s_mov_b32 s76, 24576
    buffer_load_dwordx4 v[92:95], v3, s[44:47], s76 offen nt
    v_and_b32_dpp v32, v16, v5 row_newbcast:4 row_mask:0xf bank_mask:0xf
    v_and_b32_dpp v33, v16, v6 row_newbcast:4 row_mask:0xf bank_mask:0xf
    v_and_b32_dpp v34, v16, v7 row_newbcast:4 row_mask:0xf bank_mask:0xf
    v_and_b32_dpp v35, v16, v8 row_newbcast:4 row_mask:0xf bank_mask:0xf
    s_waitcnt vmcnt(7)
    s_nop 0
    v_mfma_f32_16x16x32_bf16 v[28:31], v[32:35], v[72:75], v[28:31]
    s_add_u32 s76, s41, 65536
    s_and_b32 s76, s76, 0xfffff
    buffer_load_dwordx4 v[64:67], v2, s[36:39], s76 offen offset:0 nt
    s_waitcnt vmcnt(7)
    v_dot2_f32_bf16 v22, v60, v10, 0
    v_dot2_f32_bf16 v22, v61, v11, v22
    v_dot2_f32_bf16 v22, v62, v12, v22
    v_dot2_f32_bf16 v22, v63, v13, v22
    s_add_u32 s76, s41, 98304
    s_and_b32 s76, s76, 0xfffff
    buffer_load_dwordx4 v[52:55], v2, s[32:35], s76 offen offset:1024 nt
    s_mov_b32 s76, 32768
    buffer_load_dwordx4 v[96:99], v3, s[44:47], s76 offen nt
    v_and_b32_dpp v36, v16, v5 row_newbcast:12 row_mask:0xf bank_mask:0xf
    v_and_b32_dpp v37, v16, v6 row_newbcast:12 row_mask:0xf bank_mask:0xf
    v_and_b32_dpp v38, v16, v7 row_newbcast:12 row_mask:0xf bank_mask:0xf
    v_and_b32_dpp v39, v16, v8 row_newbcast:12 row_mask:0xf bank_mask:0xf
    v_add_f32_dpp v18, v23, v23 row_half_mirror row_mask:0xf bank_mask:0x5
    v_add_f32_dpp v24, v21, v21 row_ror:8 row_mask:0xf bank_mask:0x3
    s_nop 1
    v_add_f32_dpp v24, v22, v22 row_ror:8 row_mask:0xf bank_mask:0xc
    s_nop 1
    v_add_f32_dpp v18, v24, v24 row_half_mirror row_mask:0xf bank_mask:0xa
    s_nop 1
    v_add_f32_dpp v18, v18, v18 quad_perm:[1,0,3,2] row_mask:0xf bank_mask:0xf
    s_nop 1
    v_add_f32_dpp v18, v18, v18 quad_perm:[2,3,0,1] row_mask:0xf bank_mask:0xf
    v_cvt_pk_bf16_f32 v18, v18, v18
    v_and_b32 v18, 0xffff0000, v18
    v_mul_f32 v18, 0x3db504f3, v18
    v_cvt_pk_bf16_f32 v18, v18, v18
    v_and_b32 v18, 0xffff0000, v18
    s_nop 1
    v_max_f32_dpp v26, v18, v18 row_ror:4 row_mask:0xf bank_mask:0xf
    s_nop 1
    v_max_f32_dpp v26, v26, v26 row_ror:8 row_mask:0xf bank_mask:0xf
    s_nop 1
    v_max_f32_dpp v26, v26, v26 row_bcast:15 row_mask:0xa bank_mask:0xf
    s_nop 1
    v_max_f32_dpp v26, v26, v26 row_bcast:31 row_mask:0xc bank_mask:0xf
    s_nop 0
    v_readlane_b32 s100, v26, 63
    s_nop 1
    v_max_f32 v26, s100, v14
    v_mul_f32 v27, s30, v26
    v_fma_f32 v25, v18, s30, -v27
    v_exp_f32 v25, v25
    v_fma_f32 v17, v14, s30, -v27
    v_exp_f32 v17, v17
    s_nop 0
    v_fma_f32 v15, v15, v17, v25
    v_cvt_pk_bf16_f32 v16, v25, v25
    v_mov_b32 v14, v26
    s_waitcnt vmcnt(8)
    v_mfma_f32_16x16x32_bf16 v[28:31], v[36:39], v[76:79], v[28:31]
    s_add_u32 s76, s41, 65536
    s_and_b32 s76, s76, 0xfffff
    buffer_load_dwordx4 v[68:71], v2, s[36:39], s76 offen offset:1024 nt
    s_mov_b32 s76, 40960
    buffer_load_dwordx4 v[100:103], v3, s[44:47], s76 offen nt
    s_waitcnt vmcnt(6)
    v_dot2_f32_bf16 v19, v48, v10, 0
    v_dot2_f32_bf16 v19, v49, v11, v19
    v_dot2_f32_bf16 v19, v50, v12, v19
    v_dot2_f32_bf16 v19, v51, v13, v19
    s_add_u32 s76, s41, 98304
    s_and_b32 s76, s76, 0xfffff
    buffer_load_dwordx4 v[56:59], v2, s[32:35], s76 offen offset:2048 nt
    v_and_b32_dpp v32, v16, v5 row_newbcast:0 row_mask:0xf bank_mask:0xf
    v_and_b32_dpp v33, v16, v6 row_newbcast:0 row_mask:0xf bank_mask:0xf
    v_and_b32_dpp v34, v16, v7 row_newbcast:0 row_mask:0xf bank_mask:0xf
    v_and_b32_dpp v35, v16, v8 row_newbcast:0 row_mask:0xf bank_mask:0xf
    v_mul_f32 v28, v28, v17
    v_mul_f32 v29, v29, v17
    v_mul_f32 v30, v30, v17
    v_mul_f32 v31, v31, v17
    s_waitcnt vmcnt(5)
    s_nop 0
    v_mfma_f32_16x16x32_bf16 v[28:31], v[32:35], v[64:67], v[28:31]
    s_add_u32 s76, s41, 65536
    s_and_b32 s76, s76, 0xfffff
    buffer_load_dwordx4 v[72:75], v2, s[36:39], s76 offen offset:2048 nt
    s_mov_b32 s76, 49152
    buffer_load_dwordx4 v[104:107], v3, s[44:47], s76 offen nt
    s_waitcnt vmcnt(6)
    v_dot2_f32_bf16 v20, v52, v10, 0
    v_dot2_f32_bf16 v20, v53, v11, v20
    v_dot2_f32_bf16 v20, v54, v12, v20
    v_dot2_f32_bf16 v20, v55, v13, v20
    s_add_u32 s76, s41, 98304
    s_and_b32 s76, s76, 0xfffff
    buffer_load_dwordx4 v[60:63], v2, s[32:35], s76 offen offset:3072 nt
    s_mov_b32 s76, 57344
    buffer_load_dwordx4 v[108:111], v3, s[44:47], s76 offen nt
    v_add_f32_dpp v23, v19, v19 row_ror:8 row_mask:0xf bank_mask:0x3
    s_nop 1
    v_add_f32_dpp v23, v20, v20 row_ror:8 row_mask:0xf bank_mask:0xc
    v_and_b32_dpp v36, v16, v5 row_newbcast:8 row_mask:0xf bank_mask:0xf
    v_and_b32_dpp v37, v16, v6 row_newbcast:8 row_mask:0xf bank_mask:0xf
    v_and_b32_dpp v38, v16, v7 row_newbcast:8 row_mask:0xf bank_mask:0xf
    v_and_b32_dpp v39, v16, v8 row_newbcast:8 row_mask:0xf bank_mask:0xf
    s_waitcnt vmcnt(6)
    s_nop 0
    v_mfma_f32_16x16x32_bf16 v[28:31], v[36:39], v[68:71], v[28:31]
    s_add_u32 s76, s41, 65536
    s_and_b32 s76, s76, 0xfffff
    buffer_load_dwordx4 v[76:79], v2, s[36:39], s76 offen offset:3072 nt
    s_waitcnt vmcnt(5)
    v_dot2_f32_bf16 v21, v56, v10, 0
    v_dot2_f32_bf16 v21, v57, v11, v21
    v_dot2_f32_bf16 v21, v58, v12, v21
    v_dot2_f32_bf16 v21, v59, v13, v21
    s_add_u32 s76, s41, 131072
    s_and_b32 s76, s76, 0xfffff
    buffer_load_dwordx4 v[48:51], v2, s[32:35], s76 offen offset:0 nt
    s_mov_b32 s76, 65536
    buffer_load_dwordx4 v[112:115], v3, s[44:47], s76 offen nt
    v_and_b32_dpp v32, v16, v5 row_newbcast:4 row_mask:0xf bank_mask:0xf
    v_and_b32_dpp v33, v16, v6 row_newbcast:4 row_mask:0xf bank_mask:0xf
    v_and_b32_dpp v34, v16, v7 row_newbcast:4 row_mask:0xf bank_mask:0xf
    v_and_b32_dpp v35, v16, v8 row_newbcast:4 row_mask:0xf bank_mask:0xf
    s_waitcnt vmcnt(6)
    s_nop 0
    v_mfma_f32_16x16x32_bf16 v[28:31], v[32:35], v[72:75], v[28:31]
    s_add_u32 s76, s41, 98304
    s_and_b32 s76, s76, 0xfffff
    buffer_load_dwordx4 v[64:67], v2, s[36:39], s76 offen offset:0 nt
    s_mov_b32 s76, 73728
    buffer_load_dwordx4 v[116:119], v3, s[44:47], s76 offen nt
    s_waitcnt vmcnt(6)
    v_dot2_f32_bf16 v22, v60, v10, 0
    v_dot2_f32_bf16 v22, v61, v11, v22
    v_dot2_f32_bf16 v22, v62, v12, v22
    v_dot2_f32_bf16 v22, v63, v13, v22
    s_add_u32 s76, s41, 131072
    s_and_b32 s76, s76, 0xfffff
    buffer_load_dwordx4 v[52:55], v2, s[32:35], s76 offen offset:1024 nt
    v_and_b32_dpp v36, v16, v5 row_newbcast:12 row_mask:0xf bank_mask:0xf
    v_and_b32_dpp v37, v16, v6 row_newbcast:12 row_mask:0xf bank_mask:0xf
    v_and_b32_dpp v38, v16, v7 row_newbcast:12 row_mask:0xf bank_mask:0xf
    v_and_b32_dpp v39, v16, v8 row_newbcast:12 row_mask:0xf bank_mask:0xf
    v_add_f32_dpp v18, v23, v23 row_half_mirror row_mask:0xf bank_mask:0x5
    v_add_f32_dpp v24, v21, v21 row_ror:8 row_mask:0xf bank_mask:0x3
    s_nop 1
    v_add_f32_dpp v24, v22, v22 row_ror:8 row_mask:0xf bank_mask:0xc
    s_nop 1
    v_add_f32_dpp v18, v24, v24 row_half_mirror row_mask:0xf bank_mask:0xa
    s_nop 1
    v_add_f32_dpp v18, v18, v18 quad_perm:[1,0,3,2] row_mask:0xf bank_mask:0xf
    s_nop 1
    v_add_f32_dpp v18, v18, v18 quad_perm:[2,3,0,1] row_mask:0xf bank_mask:0xf
    v_cvt_pk_bf16_f32 v18, v18, v18
    v_and_b32 v18, 0xffff0000, v18
    v_mul_f32 v18, 0x3db504f3, v18
    v_cvt_pk_bf16_f32 v18, v18, v18
    v_and_b32 v18, 0xffff0000, v18
    s_nop 1
    v_max_f32_dpp v26, v18, v18 row_ror:4 row_mask:0xf bank_mask:0xf
    s_nop 1
    v_max_f32_dpp v26, v26, v26 row_ror:8 row_mask:0xf bank_mask:0xf
    s_nop 1
    v_max_f32_dpp v26, v26, v26 row_bcast:15 row_mask:0xa bank_mask:0xf
    s_nop 1
    v_max_f32_dpp v26, v26, v26 row_bcast:31 row_mask:0xc bank_mask:0xf
    s_nop 0
    v_readlane_b32 s100, v26, 63
    s_nop 1
    v_max_f32 v26, s100, v14
    v_mul_f32 v27, s30, v26
    v_fma_f32 v25, v18, s30, -v27
    v_exp_f32 v25, v25
    v_fma_f32 v17, v14, s30, -v27
    v_exp_f32 v17, v17
    s_nop 0
    v_fma_f32 v15, v15, v17, v25
    v_cvt_pk_bf16_f32 v16, v25, v25
    v_mov_b32 v14, v26
    s_waitcnt vmcnt(5)
    v_mfma_f32_16x16x32_bf16 v[28:31], v[36:39], v[76:79], v[28:31]
    s_add_u32 s76, s41, 98304
    s_and_b32 s76, s76, 0xfffff
    buffer_load_dwordx4 v[68:71], v2, s[36:39], s76 offen offset:1024 nt
    s_mov_b32 s76, 81920
    buffer_load_dwordx4 v[120:123], v3, s[44:47], s76 offen nt
    s_waitcnt vmcnt(6)
    v_dot2_f32_bf16 v19, v48, v10, 0
    v_dot2_f32_bf16 v19, v49, v11, v19
    v_dot2_f32_bf16 v19, v50, v12, v19
    v_dot2_f32_bf16 v19, v51, v13, v19
    s_add_u32 s76, s41, 131072
    s_and_b32 s76, s76, 0xfffff
    buffer_load_dwordx4 v[56:59], v2, s[32:35], s76 offen offset:2048 nt
    s_mov_b32 s76, 90112
    buffer_load_dwordx4 v[124:127], v3, s[44:47], s76 offen nt
    v_and_b32_dpp v32, v16, v5 row_newbcast:0 row_mask:0xf bank_mask:0xf
    v_and_b32_dpp v33, v16, v6 row_newbcast:0 row_mask:0xf bank_mask:0xf
    v_and_b32_dpp v34, v16, v7 row_newbcast:0 row_mask:0xf bank_mask:0xf
    v_and_b32_dpp v35, v16, v8 row_newbcast:0 row_mask:0xf bank_mask:0xf
    v_mul_f32 v28, v28, v17
    v_mul_f32 v29, v29, v17
    v_mul_f32 v30, v30, v17
    v_mul_f32 v31, v31, v17
    s_waitcnt vmcnt(6)
    s_nop 0
    v_mfma_f32_16x16x32_bf16 v[28:31], v[32:35], v[64:67], v[28:31]
    s_add_u32 s76, s41, 98304
    s_and_b32 s76, s76, 0xfffff
    buffer_load_dwordx4 v[72:75], v2, s[36:39], s76 offen offset:2048 nt
    s_waitcnt vmcnt(5)
    v_dot2_f32_bf16 v20, v52, v10, 0
    v_dot2_f32_bf16 v20, v53, v11, v20
    v_dot2_f32_bf16 v20, v54, v12, v20
    v_dot2_f32_bf16 v20, v55, v13, v20
    s_add_u32 s76, s41, 131072
    s_and_b32 s76, s76, 0xfffff
    buffer_load_dwordx4 v[60:63], v2, s[32:35], s76 offen offset:3072 nt
    s_mov_b32 s76, 98304
    buffer_load_dwordx4 v[128:131], v3, s[44:47], s76 offen nt
    v_mov_b32 v26, 0
    v_mov_b32 v9, 0
    global_load_dword v9, v26, s[26:27] sc1
    s_and_b32 s100, s2, 7
    s_lshl_b32 s100, s100, 13
    s_add_u32 s100, s100, 3146240
    buffer_load_dwordx4 v[164:167], v26, s[52:55], s100 offen sc1
    v_add_f32_dpp v23, v19, v19 row_ror:8 row_mask:0xf bank_mask:0x3
    s_nop 1
    v_add_f32_dpp v23, v20, v20 row_ror:8 row_mask:0xf bank_mask:0xc
    v_and_b32_dpp v36, v16, v5 row_newbcast:8 row_mask:0xf bank_mask:0xf
    v_and_b32_dpp v37, v16, v6 row_newbcast:8 row_mask:0xf bank_mask:0xf
    v_and_b32_dpp v38, v16, v7 row_newbcast:8 row_mask:0xf bank_mask:0xf
    v_and_b32_dpp v39, v16, v8 row_newbcast:8 row_mask:0xf bank_mask:0xf
    s_waitcnt vmcnt(8)
    s_nop 0
    v_mfma_f32_16x16x32_bf16 v[28:31], v[36:39], v[68:71], v[28:31]
    s_add_u32 s76, s41, 98304
    s_and_b32 s76, s76, 0xfffff
    buffer_load_dwordx4 v[76:79], v2, s[36:39], s76 offen offset:3072 nt
    s_mov_b32 s76, 106496
    buffer_load_dwordx4 v[132:135], v3, s[44:47], s76 offen nt
    s_waitcnt vmcnt(8)
    v_dot2_f32_bf16 v21, v56, v10, 0
    v_dot2_f32_bf16 v21, v57, v11, v21
    v_dot2_f32_bf16 v21, v58, v12, v21
    v_dot2_f32_bf16 v21, v59, v13, v21
    s_add_u32 s76, s41, 163840
    s_and_b32 s76, s76, 0xfffff
    buffer_load_dwordx4 v[48:51], v2, s[32:35], s76 offen offset:0 nt
    v_and_b32_dpp v32, v16, v5 row_newbcast:4 row_mask:0xf bank_mask:0xf
    v_and_b32_dpp v33, v16, v6 row_newbcast:4 row_mask:0xf bank_mask:0xf
    v_and_b32_dpp v34, v16, v7 row_newbcast:4 row_mask:0xf bank_mask:0xf
    v_and_b32_dpp v35, v16, v8 row_newbcast:4 row_mask:0xf bank_mask:0xf
    s_waitcnt vmcnt(7)
    s_nop 0
    v_mfma_f32_16x16x32_bf16 v[28:31], v[32:35], v[72:75], v[28:31]
    s_add_u32 s76, s41, 131072
    s_and_b32 s76, s76, 0xfffff
    buffer_load_dwordx4 v[64:67], v2, s[36:39], s76 offen offset:0 nt
    s_mov_b32 s76, 114688
    buffer_load_dwordx4 v[136:139], v3, s[44:47], s76 offen nt
    s_waitcnt vmcnt(8)
    v_dot2_f32_bf16 v22, v60, v10, 0
    v_dot2_f32_bf16 v22, v61, v11, v22
    v_dot2_f32_bf16 v22, v62, v12, v22
    v_dot2_f32_bf16 v22, v63, v13, v22
    s_add_u32 s76, s41, 163840
    s_and_b32 s76, s76, 0xfffff
    buffer_load_dwordx4 v[52:55], v2, s[32:35], s76 offen offset:1024 nt
    s_mov_b32 s76, 122880
    buffer_load_dwordx4 v[140:143], v3, s[44:47], s76 offen nt
    v_and_b32_dpp v36, v16, v5 row_newbcast:12 row_mask:0xf bank_mask:0xf
    v_and_b32_dpp v37, v16, v6 row_newbcast:12 row_mask:0xf bank_mask:0xf
    v_and_b32_dpp v38, v16, v7 row_newbcast:12 row_mask:0xf bank_mask:0xf
    v_and_b32_dpp v39, v16, v8 row_newbcast:12 row_mask:0xf bank_mask:0xf
    v_add_f32_dpp v18, v23, v23 row_half_mirror row_mask:0xf bank_mask:0x5
    v_add_f32_dpp v24, v21, v21 row_ror:8 row_mask:0xf bank_mask:0x3
    s_nop 1
    v_add_f32_dpp v24, v22, v22 row_ror:8 row_mask:0xf bank_mask:0xc
    s_nop 1
    v_add_f32_dpp v18, v24, v24 row_half_mirror row_mask:0xf bank_mask:0xa
    s_nop 1
    v_add_f32_dpp v18, v18, v18 quad_perm:[1,0,3,2] row_mask:0xf bank_mask:0xf
    s_nop 1
    v_add_f32_dpp v18, v18, v18 quad_perm:[2,3,0,1] row_mask:0xf bank_mask:0xf
    v_cvt_pk_bf16_f32 v18, v18, v18
    v_and_b32 v18, 0xffff0000, v18
    v_mul_f32 v18, 0x3db504f3, v18
    v_cvt_pk_bf16_f32 v18, v18, v18
    v_and_b32 v18, 0xffff0000, v18
    s_nop 1
    v_max_f32_dpp v26, v18, v18 row_ror:4 row_mask:0xf bank_mask:0xf
    s_nop 1
    v_max_f32_dpp v26, v26, v26 row_ror:8 row_mask:0xf bank_mask:0xf
    s_nop 1
    v_max_f32_dpp v26, v26, v26 row_bcast:15 row_mask:0xa bank_mask:0xf
    s_nop 1
    v_max_f32_dpp v26, v26, v26 row_bcast:31 row_mask:0xc bank_mask:0xf
    s_nop 0
    v_readlane_b32 s100, v26, 63
    s_nop 1
    v_max_f32 v26, s100, v14
    v_mul_f32 v27, s30, v26
    v_fma_f32 v25, v18, s30, -v27
    v_exp_f32 v25, v25
    v_fma_f32 v17, v14, s30, -v27
    v_exp_f32 v17, v17
    s_nop 0
    v_fma_f32 v15, v15, v17, v25
    v_cvt_pk_bf16_f32 v16, v25, v25
    v_mov_b32 v14, v26
    s_waitcnt vmcnt(6)
    v_mfma_f32_16x16x32_bf16 v[28:31], v[36:39], v[76:79], v[28:31]
    s_add_u32 s76, s41, 131072
    s_and_b32 s76, s76, 0xfffff
    buffer_load_dwordx4 v[68:71], v2, s[36:39], s76 offen offset:1024 nt
    s_waitcnt vmcnt(5)
    v_dot2_f32_bf16 v19, v48, v10, 0
    v_dot2_f32_bf16 v19, v49, v11, v19
    v_dot2_f32_bf16 v19, v50, v12, v19
    v_dot2_f32_bf16 v19, v51, v13, v19
    s_add_u32 s76, s41, 163840
    s_and_b32 s76, s76, 0xfffff
    buffer_load_dwordx4 v[56:59], v2, s[32:35], s76 offen offset:2048 nt
    v_and_b32_dpp v32, v16, v5 row_newbcast:0 row_mask:0xf bank_mask:0xf
    v_and_b32_dpp v33, v16, v6 row_newbcast:0 row_mask:0xf bank_mask:0xf
    v_and_b32_dpp v34, v16, v7 row_newbcast:0 row_mask:0xf bank_mask:0xf
    v_and_b32_dpp v35, v16, v8 row_newbcast:0 row_mask:0xf bank_mask:0xf
    v_mul_f32 v28, v28, v17
    v_mul_f32 v29, v29, v17
    v_mul_f32 v30, v30, v17
    v_mul_f32 v31, v31, v17
    s_waitcnt vmcnt(5)
    s_nop 0
    v_mfma_f32_16x16x32_bf16 v[28:31], v[32:35], v[64:67], v[28:31]
    s_add_u32 s76, s41, 131072
    s_and_b32 s76, s76, 0xfffff
    buffer_load_dwordx4 v[72:75], v2, s[36:39], s76 offen offset:2048 nt
    s_waitcnt vmcnt(4)
    v_dot2_f32_bf16 v20, v52, v10, 0
    v_dot2_f32_bf16 v20, v53, v11, v20
    v_dot2_f32_bf16 v20, v54, v12, v20
    v_dot2_f32_bf16 v20, v55, v13, v20
    s_add_u32 s76, s41, 163840
    s_and_b32 s76, s76, 0xfffff
    buffer_load_dwordx4 v[60:63], v2, s[32:35], s76 offen offset:3072 nt
    v_add_f32_dpp v23, v19, v19 row_ror:8 row_mask:0xf bank_mask:0x3
    s_nop 1
    v_add_f32_dpp v23, v20, v20 row_ror:8 row_mask:0xf bank_mask:0xc
    v_and_b32_dpp v36, v16, v5 row_newbcast:8 row_mask:0xf bank_mask:0xf
    v_and_b32_dpp v37, v16, v6 row_newbcast:8 row_mask:0xf bank_mask:0xf
    v_and_b32_dpp v38, v16, v7 row_newbcast:8 row_mask:0xf bank_mask:0xf
    v_and_b32_dpp v39, v16, v8 row_newbcast:8 row_mask:0xf bank_mask:0xf
    s_waitcnt vmcnt(3)
    s_nop 0
    v_mfma_f32_16x16x32_bf16 v[28:31], v[36:39], v[68:71], v[28:31]
    s_add_u32 s76, s41, 131072
    s_and_b32 s76, s76, 0xfffff
    buffer_load_dwordx4 v[76:79], v2, s[36:39], s76 offen offset:3072 nt
    s_waitcnt vmcnt(3)
    v_dot2_f32_bf16 v21, v56, v10, 0
    v_dot2_f32_bf16 v21, v57, v11, v21
    v_dot2_f32_bf16 v21, v58, v12, v21
    v_dot2_f32_bf16 v21, v59, v13, v21
    s_add_u32 s15, s41, 163840
    s_and_b32 s15, s15, 0xfffff
    s_mov_b32 s40, 196608
    s_add_u32 s60, s41, s40
    s_and_b32 s60, s60, 0xfffff
    s_add_u32 s68, s15, 2048
    s_cmp_lt_u32 s40, s69
    s_cselect_b32 s68, s60, s68
    s_cselect_b32 s60, s60, 0x100000
    s_cselect_b64 s[56:57], s[32:33], s[36:37]
    buffer_load_dwordx4 v[48:51], v2, s[56:59], s68 offen offset:0 nt
    v_and_b32_dpp v32, v16, v5 row_newbcast:4 row_mask:0xf bank_mask:0xf
    v_and_b32_dpp v33, v16, v6 row_newbcast:4 row_mask:0xf bank_mask:0xf
    v_and_b32_dpp v34, v16, v7 row_newbcast:4 row_mask:0xf bank_mask:0xf
    v_and_b32_dpp v35, v16, v8 row_newbcast:4 row_mask:0xf bank_mask:0xf
    s_waitcnt vmcnt(3)
    s_nop 0
    v_mfma_f32_16x16x32_bf16 v[28:31], v[32:35], v[72:75], v[28:31]
    s_add_u32 s76, s41, 163840
    s_and_b32 s76, s76, 0xfffff
    buffer_load_dwordx4 v[64:67], v2, s[36:39], s76 offen offset:0 nt
    s_waitcnt vmcnt(3)
    v_dot2_f32_bf16 v22, v60, v10, 0
    v_dot2_f32_bf16 v22, v61, v11, v22
    v_dot2_f32_bf16 v22, v62, v12, v22
    v_dot2_f32_bf16 v22, v63, v13, v22
    buffer_load_dwordx4 v[52:55], v2, s[56:59], s68 offen offset:1024 nt
    v_and_b32_dpp v36, v16, v5 row_newbcast:12 row_mask:0xf bank_mask:0xf
    v_and_b32_dpp v37, v16, v6 row_newbcast:12 row_mask:0xf bank_mask:0xf
    v_and_b32_dpp v38, v16, v7 row_newbcast:12 row_mask:0xf bank_mask:0xf
    v_and_b32_dpp v39, v16, v8 row_newbcast:12 row_mask:0xf bank_mask:0xf
    v_add_f32_dpp v18, v23, v23 row_half_mirror row_mask:0xf bank_mask:0x5
    v_add_f32_dpp v24, v21, v21 row_ror:8 row_mask:0xf bank_mask:0x3
    s_nop 1
    v_add_f32_dpp v24, v22, v22 row_ror:8 row_mask:0xf bank_mask:0xc
    s_nop 1
    v_add_f32_dpp v18, v24, v24 row_half_mirror row_mask:0xf bank_mask:0xa
    s_nop 1
    v_add_f32_dpp v18, v18, v18 quad_perm:[1,0,3,2] row_mask:0xf bank_mask:0xf
    s_nop 1
    v_add_f32_dpp v18, v18, v18 quad_perm:[2,3,0,1] row_mask:0xf bank_mask:0xf
    v_cvt_pk_bf16_f32 v18, v18, v18
    v_and_b32 v18, 0xffff0000, v18
    v_mul_f32 v18, 0x3db504f3, v18
    v_cvt_pk_bf16_f32 v18, v18, v18
    v_and_b32 v18, 0xffff0000, v18
    s_nop 1
    v_max_f32_dpp v26, v18, v18 row_ror:4 row_mask:0xf bank_mask:0xf
    s_nop 1
    v_max_f32_dpp v26, v26, v26 row_ror:8 row_mask:0xf bank_mask:0xf
    s_nop 1
    v_max_f32_dpp v26, v26, v26 row_bcast:15 row_mask:0xa bank_mask:0xf
    s_nop 1
    v_max_f32_dpp v26, v26, v26 row_bcast:31 row_mask:0xc bank_mask:0xf
    s_nop 0
    v_readlane_b32 s100, v26, 63
    s_nop 1
    v_max_f32 v26, s100, v14
    v_mul_f32 v27, s30, v26
    v_fma_f32 v25, v18, s30, -v27
    v_exp_f32 v25, v25
    v_fma_f32 v17, v14, s30, -v27
    v_exp_f32 v17, v17
    s_nop 0
    v_fma_f32 v15, v15, v17, v25
    v_cvt_pk_bf16_f32 v16, v25, v25
    v_mov_b32 v14, v26
    s_waitcnt vmcnt(3)
    v_mfma_f32_16x16x32_bf16 v[28:31], v[36:39], v[76:79], v[28:31]
    s_add_u32 s76, s41, 163840
    s_and_b32 s76, s76, 0xfffff
    buffer_load_dwordx4 v[68:71], v2, s[36:39], s76 offen offset:1024 nt
    v_perm_b32 v160, v84, v80, s31
    v_perm_b32 v84, v84, v80, s3
    v_mov_b32 v80, v160
    v_perm_b32 v160, v85, v81, s31
    v_perm_b32 v161, v85, v81, s3
    v_perm_b32 v81, v92, v88, s31
    v_perm_b32 v85, v92, v88, s3
    v_mov_b32 v88, v160
    v_mov_b32 v92, v161
    v_perm_b32 v160, v86, v82, s31
    v_perm_b32 v161, v86, v82, s3
    v_perm_b32 v82, v100, v96, s31
    v_perm_b32 v86, v100, v96, s3
    v_mov_b32 v96, v160
    v_mov_b32 v100, v161
    v_perm_b32 v160, v87, v83, s31
    v_perm_b32 v161, v87, v83, s3
    v_perm_b32 v83, v108, v104, s31
    v_perm_b32 v87, v108, v104, s3
    v_mov_b32 v104, v160
    v_mov_b32 v108, v161
    v_perm_b32 v160, v93, v89, s31
    v_perm_b32 v93, v93, v89, s3
    v_mov_b32 v89, v160
    v_perm_b32 v160, v94, v90, s31
    v_perm_b32 v161, v94, v90, s3
    v_perm_b32 v90, v101, v97, s31
    v_perm_b32 v94, v101, v97, s3
    v_mov_b32 v97, v160
    v_mov_b32 v101, v161
    v_perm_b32 v160, v95, v91, s31
    v_perm_b32 v161, v95, v91, s3
    v_perm_b32 v91, v109, v105, s31
    v_perm_b32 v95, v109, v105, s3
    v_mov_b32 v105, v160
    v_mov_b32 v109, v161
    v_perm_b32 v160, v102, v98, s31
    v_perm_b32 v102, v102, v98, s3
    v_mov_b32 v98, v160
    v_perm_b32 v160, v103, v99, s31
    v_perm_b32 v161, v103, v99, s3
    v_perm_b32 v99, v110, v106, s31
    v_perm_b32 v103, v110, v106, s3
    v_mov_b32 v106, v160
    v_mov_b32 v110, v161
    v_perm_b32 v160, v111, v107, s31
    v_perm_b32 v111, v111, v107, s3
    v_mov_b32 v107, v160
    v_perm_b32 v160, v116, v112, s31
    v_perm_b32 v116, v116, v112, s3
    v_mov_b32 v112, v160
    v_perm_b32 v160, v117, v113, s31
    v_perm_b32 v161, v117, v113, s3
    v_perm_b32 v113, v124, v120, s31
    v_perm_b32 v117, v124, v120, s3
    v_mov_b32 v120, v160
    v_mov_b32 v124, v161
    v_perm_b32 v160, v118, v114, s31
    v_perm_b32 v161, v118, v114, s3
    v_perm_b32 v114, v132, v128, s31
    v_perm_b32 v118, v132, v128, s3
    v_mov_b32 v128, v160
    v_mov_b32 v132, v161
    v_perm_b32 v160, v119, v115, s31
    v_perm_b32 v161, v119, v115, s3
    v_perm_b32 v115, v140, v136, s31
    v_perm_b32 v119, v140, v136, s3
    v_mov_b32 v136, v160
    v_mov_b32 v140, v161
    v_perm_b32 v160, v125, v121, s31
    v_perm_b32 v125, v125, v121, s3
    v_mov_b32 v121, v160
    v_perm_b32 v160, v126, v122, s31
    v_perm_b32 v161, v126, v122, s3
    v_perm_b32 v122, v133, v129, s31
    v_perm_b32 v126, v133, v129, s3
    v_mov_b32 v129, v160
    v_mov_b32 v133, v161
    v_perm_b32 v160, v127, v123, s31
    v_perm_b32 v161, v127, v123, s3
    v_perm_b32 v123, v141, v137, s31
    v_perm_b32 v127, v141, v137, s3
    v_mov_b32 v137, v160
    v_mov_b32 v141, v161
    v_perm_b32 v160, v134, v130, s31
    v_perm_b32 v134, v134, v130, s3
    v_mov_b32 v130, v160
    v_perm_b32 v160, v135, v131, s31
    v_perm_b32 v161, v135, v131, s3
    v_perm_b32 v131, v142, v138, s31
    v_perm_b32 v135, v142, v138, s3
    v_mov_b32 v138, v160
    v_mov_b32 v142, v161
    v_perm_b32 v160, v143, v139, s31
    v_perm_b32 v143, v143, v139, s3
    v_mov_b32 v139, v160
    s_mov_b32 s77, 400000
    v_mov_b32 v3, 0
    s_getreg_b32 s61, hwreg(HW_REG_XCC_ID, 0, 4)
    s_add_u32 s61, s61, 1
    s_nop 2
L_gn:
    v_readfirstlane_b32 s48, v9
    s_cmp_lg_u32 s48, 0
    s_cbranch_scc1 L_gn_ok
    global_load_dword v9, v3, s[26:27] sc1
    s_sub_u32 s77, s77, 1
    s_cbranch_scc1 L_end
    s_waitcnt vmcnt(0)
    s_branch L_gn
L_gn_ok:
    s_add_u32 s61, s61, s48
    v_xor_b32 v164, s61, v164
    v_bitop3_b32 v164, v164, v165, s61 bitop3:0xf6
    v_bitop3_b32 v164, v164, v166, s61 bitop3:0xf6
    v_bitop3_b32 v164, v164, v167, s61 bitop3:0xf6
    s_nop 0
    v_readfirstlane_b32 s62, v164
    s_lshr_b32 s49, s48, 8
    s_lshr_b32 s50, s48, 16
    s_lshr_b32 s51, s48, 24
    v_lshlrev_b32 v45, 9, v40
    v_bfe_u32 v25, v1, 3, 1
    v_lshl_add_u32 v45, v25, 8, v45
    v_lshl_add_u32 v45, v41, 7, v45
    v_and_b32 v25, 7, v1
    v_lshl_add_u32 v45, v25, 2, v45
    v_and_b32 v46, 1, v1
    v_lshlrev_b32 v46, 6, v46
    v_lshl_add_u32 v46, v41, 4, v46
    v_lshl_add_u32 v46, v40, 8, v46
    s_lshr_b32 s100, s72, 3
    s_lshl_b32 s100, s100, 2
    s_add_u32 s100, s100, s74
    s_and_b32 s101, s2, 7
    s_lshl_b32 s101, s101, 1
    s_add_u32 s101, s101, s73
    s_lshl_b32 s78, s73, 4
    s_add_u32 s78, s78, s100
    s_lshl_b32 s78, s78, 4
    s_add_u32 s78, s78, 1048576
    s_and_b32 s42, s2, 7
    s_lshl_b32 s42, s42, 13
    s_add_u32 s78, s78, s42
    s_cmp_eq_u32 s75, 7
    s_cselect_b32 s78, s78, 4194304
    s_add_u32 s79, s78, 2097152
    s_lshl_b32 s101, s101, 15
    s_and_b32 s42, s100, 1
    s_lshl_b32 s42, s42, 3
    s_lshr_b32 s100, s100, 1
    s_add_u32 s100, s100, s42
    s_lshl_b32 s100, s100, 7
    s_add_u32 s101, s101, s100
    s_lshl_b32 s100, s75, 12
    s_add_u32 s42, s101, s100
    s_add_u32 s43, s42, 2097152
    v_bfe_u32 v47, v42, 2, 1
    v_lshlrev_b32 v47, 11, v47
    v_and_b32 v25, 3, v42
    v_lshl_add_u32 v47, v25, 5, v47
    v_lshl_add_u32 v47, v41, 4, v47
    v_mov_b32 v4, 0xff
    s_mov_b32 s14, s15
    s_mov_b32 s15, s60
    s_add_u32 s40, s40, 32768
    s_add_u32 s60, s41, s40
    s_and_b32 s60, s60, 0xfffff
    s_add_u32 s68, s15, 2048
    s_cmp_lt_u32 s40, s69
    s_cselect_b32 s68, s60, s68
    s_cselect_b32 s60, s60, 0x100000
    s_cselect_b64 s[56:57], s[32:33], s[36:37]
    s_cmp_ge_u32 s15, 0x100000
    s_cbranch_scc1 L_epi
L_loop:
    s_waitcnt vmcnt(3)
    v_dot2_f32_bf16 v19, v48, v10, 0
    v_dot2_f32_bf16 v19, v49, v11, v19
    v_dot2_f32_bf16 v19, v50, v12, v19
    v_dot2_f32_bf16 v19, v51, v13, v19
    buffer_load_dwordx4 v[56:59], v2, s[32:35], s15 offen offset:2048 nt
    v_and_b32_dpp v32, v16, v5 row_newbcast:0 row_mask:0xf bank_mask:0xf
    v_and_b32_dpp v33, v16, v6 row_newbcast:0 row_mask:0xf bank_mask:0xf
    v_and_b32_dpp v34, v16, v7 row_newbcast:0 row_mask:0xf bank_mask:0xf
    v_and_b32_dpp v35, v16, v8 row_newbcast:0 row_mask:0xf bank_mask:0xf
    v_mul_f32 v28, v28, v17
    v_mul_f32 v29, v29, v17
    v_mul_f32 v30, v30, v17
    v_mul_f32 v31, v31, v17
    s_waitcnt vmcnt(3)
    s_nop 0
    v_mfma_f32_16x16x32_bf16 v[28:31], v[32:35], v[64:67], v[28:31]
    buffer_load_dwordx4 v[72:75], v2, s[36:39], s14 offen offset:2048 nt
    s_waitcnt vmcnt(3)
    v_dot2_f32_bf16 v20, v52, v10, 0
    v_dot2_f32_bf16 v20, v53, v11, v20
    v_dot2_f32_bf16 v20, v54, v12, v20
    v_dot2_f32_bf16 v20, v55, v13, v20
    buffer_load_dwordx4 v[60:63], v2, s[32:35], s15 offen offset:3072 nt
    v_add_f32_dpp v23, v19, v19 row_ror:8 row_mask:0xf bank_mask:0x3
    s_nop 1
    v_add_f32_dpp v23, v20, v20 row_ror:8 row_mask:0xf bank_mask:0xc
    v_and_b32_dpp v36, v16, v5 row_newbcast:8 row_mask:0xf bank_mask:0xf
    v_and_b32_dpp v37, v16, v6 row_newbcast:8 row_mask:0xf bank_mask:0xf
    v_and_b32_dpp v38, v16, v7 row_newbcast:8 row_mask:0xf bank_mask:0xf
    v_and_b32_dpp v39, v16, v8 row_newbcast:8 row_mask:0xf bank_mask:0xf
    s_waitcnt vmcnt(3)
    s_nop 0
    v_mfma_f32_16x16x32_bf16 v[28:31], v[36:39], v[68:71], v[28:31]
    buffer_load_dwordx4 v[76:79], v2, s[36:39], s14 offen offset:3072 nt
    s_waitcnt vmcnt(3)
    v_dot2_f32_bf16 v21, v56, v10, 0
    v_dot2_f32_bf16 v21, v57, v11, v21
    v_dot2_f32_bf16 v21, v58, v12, v21
    v_dot2_f32_bf16 v21, v59, v13, v21
    buffer_load_dwordx4 v[48:51], v2, s[56:59], s68 offen offset:0 nt
    v_and_b32_dpp v32, v16, v5 row_newbcast:4 row_mask:0xf bank_mask:0xf
    v_and_b32_dpp v33, v16, v6 row_newbcast:4 row_mask:0xf bank_mask:0xf
    v_and_b32_dpp v34, v16, v7 row_newbcast:4 row_mask:0xf bank_mask:0xf
    v_and_b32_dpp v35, v16, v8 row_newbcast:4 row_mask:0xf bank_mask:0xf
    s_waitcnt vmcnt(3)
    s_nop 0
    v_mfma_f32_16x16x32_bf16 v[28:31], v[32:35], v[72:75], v[28:31]
    buffer_load_dwordx4 v[64:67], v2, s[36:39], s15 offen offset:0 nt
    s_waitcnt vmcnt(3)
    v_dot2_f32_bf16 v22, v60, v10, 0
    v_dot2_f32_bf16 v22, v61, v11, v22
    v_dot2_f32_bf16 v22, v62, v12, v22
    v_dot2_f32_bf16 v22, v63, v13, v22
    buffer_load_dwordx4 v[52:55], v2, s[56:59], s68 offen offset:1024 nt
    v_and_b32_dpp v36, v16, v5 row_newbcast:12 row_mask:0xf bank_mask:0xf
    v_and_b32_dpp v37, v16, v6 row_newbcast:12 row_mask:0xf bank_mask:0xf
    v_and_b32_dpp v38, v16, v7 row_newbcast:12 row_mask:0xf bank_mask:0xf
    v_and_b32_dpp v39, v16, v8 row_newbcast:12 row_mask:0xf bank_mask:0xf
    v_add_f32_dpp v18, v23, v23 row_half_mirror row_mask:0xf bank_mask:0x5
    v_add_f32_dpp v24, v21, v21 row_ror:8 row_mask:0xf bank_mask:0x3
    s_nop 1
    v_add_f32_dpp v24, v22, v22 row_ror:8 row_mask:0xf bank_mask:0xc
    s_nop 1
    v_add_f32_dpp v18, v24, v24 row_half_mirror row_mask:0xf bank_mask:0xa
    s_nop 1
    v_add_f32_dpp v18, v18, v18 quad_perm:[1,0,3,2] row_mask:0xf bank_mask:0xf
    s_nop 1
    v_add_f32_dpp v18, v18, v18 quad_perm:[2,3,0,1] row_mask:0xf bank_mask:0xf
    v_cvt_pk_bf16_f32 v18, v18, v18
    v_and_b32 v18, 0xffff0000, v18
    v_mul_f32 v18, 0x3db504f3, v18
    v_cvt_pk_bf16_f32 v18, v18, v18
    v_and_b32 v18, 0xffff0000, v18
    s_nop 1
    v_max_f32_dpp v26, v18, v18 row_ror:4 row_mask:0xf bank_mask:0xf
    s_nop 1
    v_max_f32_dpp v26, v26, v26 row_ror:8 row_mask:0xf bank_mask:0xf
    s_nop 1
    v_max_f32_dpp v26, v26, v26 row_bcast:15 row_mask:0xa bank_mask:0xf
    s_nop 1
    v_max_f32_dpp v26, v26, v26 row_bcast:31 row_mask:0xc bank_mask:0xf
    s_nop 0
    v_readlane_b32 s100, v26, 63
    s_nop 1
    v_max_f32 v26, s100, v14
    v_mul_f32 v27, s30, v26
    v_fma_f32 v25, v18, s30, -v27
    v_exp_f32 v25, v25
    v_fma_f32 v17, v14, s30, -v27
    v_exp_f32 v17, v17
    s_nop 0
    v_fma_f32 v15, v15, v17, v25
    v_cvt_pk_bf16_f32 v16, v25, v25
    v_mov_b32 v14, v26
    s_waitcnt vmcnt(3)
    v_mfma_f32_16x16x32_bf16 v[28:31], v[36:39], v[76:79], v[28:31]
    buffer_load_dwordx4 v[68:71], v2, s[36:39], s15 offen offset:1024 nt
    s_mov_b32 s14, s15
    s_mov_b32 s15, s60
    s_add_u32 s40, s40, 32768
    s_add_u32 s60, s41, s40
    s_and_b32 s60, s60, 0xfffff
    s_add_u32 s68, s15, 2048
    s_cmp_lt_u32 s40, s69
    s_cselect_b32 s68, s60, s68
    s_cselect_b32 s60, s60, 0x100000
    s_cselect_b64 s[56:57], s[32:33], s[36:37]
    s_cmp_lt_u32 s15, 0x100000
    s_cbranch_scc1 L_loop
L_epi:
    v_add_f32_dpp v15, v15, v15 row_ror:4 row_mask:0xf bank_mask:0xf
    s_nop 1
    v_add_f32_dpp v15, v15, v15 row_ror:8 row_mask:0xf bank_mask:0xf
    s_nop 1
    v_add_f32_dpp v15, v15, v15 row_bcast:15 row_mask:0xa bank_mask:0xf
    s_nop 1
    v_add_f32_dpp v15, v15, v15 row_bcast:31 row_mask:0xc bank_mask:0xf
    v_lshlrev_b32 v27, 3, v40
    s_mov_b32 exec_lo, 0
    s_mov_b32 exec_hi, 0x80000000
    ds_write_b64 v27, v[14:15] offset:6400
    s_mov_b64 exec, -1
    v_and_b32 v27, 7, v1
    v_lshlrev_b32 v27, 3, v27
    s_waitcnt lgkmcnt(0)
    s_barrier
    ds_read_b64 v[24:25], v27 offset:6400
    v_mov_b32 v22, v9
    v_mov_b32 v23, v9
    s_waitcnt lgkmcnt(0)
    v_max_f32_dpp v20, v24, v24 quad_perm:[1,0,3,2] row_mask:0xf bank_mask:0xf
    s_nop 1
    v_max_f32_dpp v20, v20, v20 quad_perm:[2,3,0,1] row_mask:0xf bank_mask:0xf
    s_nop 1
    v_max_f32_dpp v20, v20, v20 row_half_mirror row_mask:0xf bank_mask:0xf
    v_mul_f32 v27, s30, v20
    v_fma_f32 v24, v24, s30, -v27
    v_fma_f32 v19, v18, s30, -v27
    v_fma_f32 v27, v14, s30, -v27
    v_exp_f32 v24, v24
    v_exp_f32 v19, v19
    v_exp_f32 v27, v27
    v_mul_f32 v21, v24, v25
    v_cvt_pk_bf16_f32 v16, v19, v19
    v_mul_f32 v17, v17, v27
    v_add_f32_dpp v21, v21, v21 quad_perm:[1,0,3,2] row_mask:0xf bank_mask:0xf
    s_nop 1
    v_add_f32_dpp v21, v21, v21 quad_perm:[2,3,0,1] row_mask:0xf bank_mask:0xf
    s_nop 1
    v_add_f32_dpp v21, v21, v21 row_half_mirror row_mask:0xf bank_mask:0xf
    s_mov_b64 exec, 1
    buffer_store_dwordx4 v[20:23], v3, s[52:55], s79 offen
    s_mov_b64 exec, -1
    v_mul_f32 v28, v28, v17
    v_mul_f32 v29, v29, v17
    v_mul_f32 v30, v30, v17
    v_mul_f32 v31, v31, v17
    v_and_b32_dpp v32, v16, v5 row_newbcast:4 row_mask:0xf bank_mask:0xf
    v_and_b32_dpp v33, v16, v6 row_newbcast:4 row_mask:0xf bank_mask:0xf
    v_and_b32_dpp v34, v16, v7 row_newbcast:4 row_mask:0xf bank_mask:0xf
    v_and_b32_dpp v35, v16, v8 row_newbcast:4 row_mask:0xf bank_mask:0xf
    s_waitcnt vmcnt(4)
    s_nop 0
    v_mfma_f32_16x16x32_bf16 v[28:31], v[32:35], v[48:51], v[28:31]
    v_and_b32_dpp v36, v16, v5 row_newbcast:0 row_mask:0xf bank_mask:0xf
    v_and_b32_dpp v37, v16, v6 row_newbcast:0 row_mask:0xf bank_mask:0xf
    v_and_b32_dpp v38, v16, v7 row_newbcast:0 row_mask:0xf bank_mask:0xf
    v_and_b32_dpp v39, v16, v8 row_newbcast:0 row_mask:0xf bank_mask:0xf
    s_waitcnt vmcnt(3)
    s_nop 0
    v_mfma_f32_16x16x32_bf16 v[28:31], v[36:39], v[64:67], v[28:31]
    v_and_b32_dpp v32, v16, v5 row_newbcast:12 row_mask:0xf bank_mask:0xf
    v_and_b32_dpp v33, v16, v6 row_newbcast:12 row_mask:0xf bank_mask:0xf
    v_and_b32_dpp v34, v16, v7 row_newbcast:12 row_mask:0xf bank_mask:0xf
    v_and_b32_dpp v35, v16, v8 row_newbcast:12 row_mask:0xf bank_mask:0xf
    s_waitcnt vmcnt(2)
    s_nop 0
    v_mfma_f32_16x16x32_bf16 v[28:31], v[32:35], v[52:55], v[28:31]
    v_and_b32_dpp v36, v16, v5 row_newbcast:8 row_mask:0xf bank_mask:0xf
    v_and_b32_dpp v37, v16, v6 row_newbcast:8 row_mask:0xf bank_mask:0xf
    v_and_b32_dpp v38, v16, v7 row_newbcast:8 row_mask:0xf bank_mask:0xf
    v_and_b32_dpp v39, v16, v8 row_newbcast:8 row_mask:0xf bank_mask:0xf
    s_waitcnt vmcnt(1)
    s_nop 0
    v_mfma_f32_16x16x32_bf16 v[28:31], v[36:39], v[68:71], v[28:31]
    s_mov_b32 exec_hi, 0
    s_nop 6
    ds_write2_b32 v45, v28, v29 offset0:0 offset1:8
    ds_write2_b32 v45, v30, v31 offset0:16 offset1:24
    s_mov_b32 exec_hi, -1
    s_waitcnt lgkmcnt(0)
    s_barrier
    ds_read_b64 v[144:145], v43 offset:0
    ds_read_b64 v[146:147], v43 offset:512
    ds_read_b64 v[148:149], v43 offset:1024
    ds_read_b64 v[150:151], v43 offset:1536
    ds_read_b64 v[152:153], v43 offset:2048
    ds_read_b64 v[154:155], v43 offset:2560
    ds_read_b64 v[156:157], v43 offset:3072
    ds_read_b64 v[158:159], v43 offset:3584
    s_waitcnt lgkmcnt(6)
    v_pk_add_f32 v[144:145], v[144:145], v[146:147]
    s_waitcnt lgkmcnt(4)
    v_pk_add_f32 v[148:149], v[148:149], v[150:151]
    v_pk_add_f32 v[144:145], v[144:145], v[148:149]
    s_waitcnt lgkmcnt(2)
    v_pk_add_f32 v[152:153], v[152:153], v[154:155]
    s_waitcnt lgkmcnt(0)
    v_pk_add_f32 v[156:157], v[156:157], v[158:159]
    v_pk_add_f32 v[152:153], v[152:153], v[156:157]
    v_pk_add_f32 v[144:145], v[144:145], v[152:153]
    v_cvt_pk_bf16_f32 v144, v144, v145
    ds_write_b32 v44, v144
    ds_read_b128 v[32:35], v46 offset:4096
    ds_read_b128 v[36:39], v46 offset:4224
    s_waitcnt lgkmcnt(1)
    v_mfma_f32_16x16x32_bf16 v[48:51], v[32:35], v[80:83], 0
    v_mfma_f32_16x16x32_bf16 v[52:55], v[32:35], v[84:87], 0
    v_mfma_f32_16x16x32_bf16 v[56:59], v[32:35], v[88:91], 0
    v_mfma_f32_16x16x32_bf16 v[60:63], v[32:35], v[92:95], 0
    v_mfma_f32_16x16x32_bf16 v[64:67], v[32:35], v[96:99], 0
    v_mfma_f32_16x16x32_bf16 v[68:71], v[32:35], v[100:103], 0
    v_mfma_f32_16x16x32_bf16 v[72:75], v[32:35], v[104:107], 0
    v_mfma_f32_16x16x32_bf16 v[76:79], v[32:35], v[108:111], 0
    s_waitcnt lgkmcnt(0)
    v_mfma_f32_16x16x32_bf16 v[48:51], v[36:39], v[112:115], v[48:51]
    v_mfma_f32_16x16x32_bf16 v[52:55], v[36:39], v[116:119], v[52:55]
    v_mfma_f32_16x16x32_bf16 v[56:59], v[36:39], v[120:123], v[56:59]
    v_mfma_f32_16x16x32_bf16 v[60:63], v[36:39], v[124:127], v[60:63]
    v_mfma_f32_16x16x32_bf16 v[64:67], v[36:39], v[128:131], v[64:67]
    v_mfma_f32_16x16x32_bf16 v[68:71], v[36:39], v[132:135], v[68:71]
    v_mfma_f32_16x16x32_bf16 v[72:75], v[36:39], v[136:139], v[72:75]
    v_mfma_f32_16x16x32_bf16 v[76:79], v[36:39], v[140:143], v[76:79]
    s_nop 0
    v_add_f32_dpp v28, v49, v48 row_ror:8 row_mask:0x1 bank_mask:0xf
    v_add_f32_dpp v29, v53, v52 row_ror:8 row_mask:0x1 bank_mask:0xf
    v_add_f32_dpp v30, v57, v56 row_ror:8 row_mask:0x1 bank_mask:0xf
    v_add_f32_dpp v31, v61, v60 row_ror:8 row_mask:0x1 bank_mask:0xf
    v_add_f32_dpp v28, v65, v64 row_ror:8 row_mask:0x2 bank_mask:0xf
    v_add_f32_dpp v29, v69, v68 row_ror:8 row_mask:0x2 bank_mask:0xf
    v_add_f32_dpp v30, v73, v72 row_ror:8 row_mask:0x2 bank_mask:0xf
    v_add_f32_dpp v31, v77, v76 row_ror:8 row_mask:0x2 bank_mask:0xf
    v_bfi_b32 v28, v4, s48, v28
    v_bfi_b32 v29, v4, s49, v29
    v_bfi_b32 v30, v4, s50, v30
    v_bfi_b32 v31, v4, s51, v31
    s_mov_b64 exec, 0x00ff00ff
    buffer_store_dwordx4 v[28:31], v47, s[52:55], s43 offen
    s_cmp_eq_u32 s62, 0
    s_cbranch_scc1 L_nowt
    s_waitcnt vmcnt(0)
    buffer_store_dwordx4 v[28:31], v47, s[52:55], s42 offen sc1
    s_mov_b64 exec, 1
    buffer_store_dwordx4 v[20:23], v3, s[52:55], s78 offen sc1
L_nowt:
    s_mov_b64 exec, -1
    s_cmp_ge_u32 s2, 43
    s_cbranch_scc1 L_exit
    v_lshlrev_b32 v17, 3, v42
    v_lshl_add_u32 v17, v41, 1, v17
    v_lshl_add_u32 v17, v40, 7, v17
    global_load_ushort v36, v17, s[4:5]
    global_load_ushort v37, v17, s[4:5] offset:1024
    s_and_b32 s100, s2, 7
    s_mul_i32 s101, s100, 5
    s_min_u32 s100, s100, 3
    s_add_u32 s101, s101, s100
    s_lshr_b32 s100, s2, 3
    s_add_u32 s70, s101, s100
    s_lshl_b32 s100, s70, 6
    s_add_u32 s56, s18, s100
    s_addc_u32 s57, s19, 0
    s_add_u32 s60, s20, s100
    s_addc_u32 s61, s21, 0
    s_sub_u32 s58, 1409024, s100
    s_mov_b32 s62, s58
    s_lshl_b32 s100, s70, 15
    s_add_u32 s64, s22, s100
    s_addc_u32 s65, s23, 0
    s_mov_b32 s66, 0x8000
    s_mov_b32 s59, 0x20000
    s_mov_b32 s63, 0x20000
    s_mov_b32 s67, 0x20000
    v_lshrrev_b32 v25, 2, v1
    v_lshl_add_u32 v25, v40, 6, v25
    v_mul_u32_u24 v46, 2752, v25
    v_and_b32 v25, 3, v1
    v_lshl_add_u32 v46, v25, 4, v46
    v_lshrrev_b32 v25, 3, v1
    v_lshlrev_b32 v47, 10, v25
    v_lshl_add_u32 v47, v40, 7, v47
    v_and_b32 v25, 7, v1
    v_lshl_add_u32 v47, v25, 4, v47
    s_mul_i32 s71, s75, 12288
    s_add_u32 s71, s71, 16384
    s_add_u32 m0, s71, 0
    s_mov_b32 s76, 0
    buffer_load_dwordx4 v46, s[56:59], s76 offen nt lds
    s_add_u32 m0, s71, 1024
    s_mov_b32 s76, 44032
    buffer_load_dwordx4 v46, s[56:59], s76 offen nt lds
    s_add_u32 m0, s71, 2048
    s_mov_b32 s76, 88064
    buffer_load_dwordx4 v46, s[56:59], s76 offen nt lds
    s_add_u32 m0, s71, 3072
    s_mov_b32 s76, 132096
    buffer_load_dwordx4 v46, s[56:59], s76 offen nt lds
    s_add_u32 m0, s71, 4096
    s_mov_b32 s76, 0
    buffer_load_dwordx4 v46, s[60:63], s76 offen nt lds
    s_add_u32 m0, s71, 5120
    s_mov_b32 s76, 44032
    buffer_load_dwordx4 v46, s[60:63], s76 offen nt lds
    s_add_u32 m0, s71, 6144
    s_mov_b32 s76, 88064
    buffer_load_dwordx4 v46, s[60:63], s76 offen nt lds
    s_add_u32 m0, s71, 7168
    s_mov_b32 s76, 132096
    buffer_load_dwordx4 v46, s[60:63], s76 offen nt lds
    s_add_u32 m0, s71, 8192
    s_mov_b32 s76, 0
    buffer_load_dwordx4 v47, s[64:67], s76 offen nt lds
    s_add_u32 m0, s71, 9216
    s_mov_b32 s76, 8192
    buffer_load_dwordx4 v47, s[64:67], s76 offen nt lds
    s_add_u32 m0, s71, 10240
    s_mov_b32 s76, 16384
    buffer_load_dwordx4 v47, s[64:67], s76 offen nt lds
    s_add_u32 m0, s71, 11264
    s_mov_b32 s76, 24576
    buffer_load_dwordx4 v47, s[64:67], s76 offen nt lds
    v_lshrrev_b32 v27, 2, v42
    v_lshl_add_u32 v27, v41, 3, v27
    v_and_b32 v26, 3, v42
    v_lshlrev_b32 v26, 3, v26
    v_add_u32 v26, s71, v26
    v_lshl_add_u32 v25, v27, 6, v26
    v_lshl_add_u32 v24, v27, 7, v26
    v_mov_b32 v2, v25
    v_mov_b32 v3, v24
    v_and_b32 v27, 1, v42
    v_lshlrev_b32 v26, 10, v27
    v_lshl_add_u32 v26, v40, 7, v26
    v_lshl_add_u32 v26, v41, 4, v26
    v_add_u32 v26, 10240, v26
    v_lshlrev_b32 v25, 6, v27
    v_lshl_add_u32 v25, v40, 8, v25
    v_lshl_add_u32 v25, v41, 4, v25
    v_add_u32 v25, 4096, v25
    v_mov_b32 v5, v26
    v_lshrrev_b32 v24, 1, v42
    v_mov_b32 v23, 6144
    v_cmp_eq_u32 vcc, 0, v24
    s_nop 1
    v_cndmask_b32 v9, v23, v25, vcc
    v_cmp_eq_u32 vcc, 1, v24
    s_nop 1
    v_cndmask_b32 v10, v23, v25, vcc
    v_cmp_eq_u32 vcc, 2, v24
    s_nop 1
    v_cndmask_b32 v11, v23, v25, vcc
    v_cmp_eq_u32 vcc, 3, v24
    s_nop 1
    v_cndmask_b32 v12, v23, v25, vcc
    v_lshlrev_b32 v13, 3, v0
    v_and_b32 v23, 3, v24
    v_lshl_add_u32 v23, v40, 2, v23
    v_mul_u32_u24 v14, 6144, v23
    v_lshl_add_u32 v14, v27, 6, v14
    v_lshl_add_u32 v14, v41, 4, v14
    s_lshl_b32 s68, s70, 7
    s_add_u32 s68, s68, 1376256
    v_lshlrev_b32 v15, 2, v1
    v_add_u32 v15, 12288, v15
    v_and_b32 v16, 0x3e, v1
    v_lshl_add_u32 v16, v27, 6, v16
    v_lshl_add_u32 v16, v40, 8, v16
    v_add_u32 v16, 4096, v16
    v_lshlrev_b32 v21, 4, v1
    v_add_u32 v22, 16384, v21
    s_and_b32 s69, s2, 7
    s_lshl_b32 s69, s69, 15
    s_lshl_b32 s100, s75, 11
    s_add_u32 s69, s69, s100
    s_add_u32 s69, s69, 1114112
    v_lshlrev_b32 v38, 4, v40
    v_lshl_add_u32 v38, v41, 2, v38
    v_lshlrev_b32 v39, 3, v42
    v_mov_b32 v34, 0x3b000000
    v_mov_b32 v35, 0x3b000000
    v_mov_b32 v44, 0x3727c5ac
    v_mov_b32 v45, 0x3727c5ac
    s_mov_b32 s77, 400000
    s_waitcnt vmcnt(4)
    ds_read_b64_tr_b16 v[48:49], v2 offset:0
    ds_read_b64_tr_b16 v[50:51], v2 offset:256
    ds_read_b64_tr_b16 v[52:53], v2 offset:32
    ds_read_b64_tr_b16 v[54:55], v2 offset:288
    ds_read_b64_tr_b16 v[56:57], v2 offset:4096
    ds_read_b64_tr_b16 v[58:59], v2 offset:4352
    ds_read_b64_tr_b16 v[60:61], v2 offset:4128
    ds_read_b64_tr_b16 v[62:63], v2 offset:4384
    ds_read_b64_tr_b16 v[64:65], v2 offset:2048
    ds_read_b64_tr_b16 v[66:67], v2 offset:2304
    ds_read_b64_tr_b16 v[68:69], v2 offset:2080
    ds_read_b64_tr_b16 v[70:71], v2 offset:2336
    ds_read_b64_tr_b16 v[72:73], v2 offset:6144
    ds_read_b64_tr_b16 v[74:75], v2 offset:6400
    ds_read_b64_tr_b16 v[76:77], v2 offset:6176
    ds_read_b64_tr_b16 v[78:79], v2 offset:6432
    s_waitcnt lgkmcnt(0)
    s_waitcnt vmcnt(0)
    ds_read_b64_tr_b16 v[80:81], v3 offset:8192
    ds_read_b64_tr_b16 v[82:83], v3 offset:8704
    ds_read_b64_tr_b16 v[84:85], v3 offset:8224
    ds_read_b64_tr_b16 v[86:87], v3 offset:8736
    ds_read_b64_tr_b16 v[88:89], v3 offset:8256
    ds_read_b64_tr_b16 v[90:91], v3 offset:8768
    ds_read_b64_tr_b16 v[92:93], v3 offset:8288
    ds_read_b64_tr_b16 v[94:95], v3 offset:8800
    v_mov_b32 v144, 0x3f803f80
    v_mov_b32 v145, 0x3f803f80
    v_mov_b32 v146, 0x3f803f80
    v_mov_b32 v147, 0x3f803f80
    s_nop 1
    v_mfma_f32_16x16x32_bf16 v[112:115], v[144:147], v[48:51], 0
    v_mfma_f32_16x16x32_bf16 v[116:119], v[144:147], v[52:55], 0
    v_mfma_f32_16x16x32_bf16 v[120:123], v[144:147], v[56:59], 0
    v_mfma_f32_16x16x32_bf16 v[124:127], v[144:147], v[60:63], 0
    v_mfma_f32_16x16x32_bf16 v[112:115], v[144:147], v[64:67], v[112:115]
    v_mfma_f32_16x16x32_bf16 v[116:119], v[144:147], v[68:71], v[116:119]
    v_mfma_f32_16x16x32_bf16 v[120:123], v[144:147], v[72:75], v[120:123]
    v_mfma_f32_16x16x32_bf16 v[124:127], v[144:147], v[76:79], v[124:127]
    s_nop 5
    v_mov_b32_dpp v112, v116 quad_perm:[0,1,2,3] row_mask:0x2 bank_mask:0xf
    v_mov_b32_dpp v113, v117 quad_perm:[0,1,2,3] row_mask:0x2 bank_mask:0xf
    s_nop 0
    v_mov_b32_dpp v112, v120 quad_perm:[0,1,2,3] row_mask:0x4 bank_mask:0xf
    v_mov_b32_dpp v113, v121 quad_perm:[0,1,2,3] row_mask:0x4 bank_mask:0xf
    s_nop 0
    v_mov_b32_dpp v112, v124 quad_perm:[0,1,2,3] row_mask:0x8 bank_mask:0xf
    v_mov_b32_dpp v113, v125 quad_perm:[0,1,2,3] row_mask:0x8 bank_mask:0xf
    v_add_u32 v8, 114688, v13
    ds_write_b64 v8, v[112:113]
    v_add_u32 v8, 102400, v15
    s_waitcnt lgkmcnt(0)
    s_barrier
    ds_read2st64_b32 v[144:145], v8 offset0:0 offset1:1
    ds_read2st64_b32 v[146:147], v8 offset0:2 offset1:3
    ds_read2st64_b32 v[148:149], v8 offset0:4 offset1:5
    ds_read2st64_b32 v[150:151], v8 offset0:6 offset1:7
    ds_read2st64_b32 v[152:153], v8 offset0:8 offset1:9
    ds_read2st64_b32 v[154:155], v8 offset0:10 offset1:11
    ds_read2st64_b32 v[156:157], v8 offset0:12 offset1:13
    ds_read2st64_b32 v[158:159], v8 offset0:14 offset1:15
    s_waitcnt lgkmcnt(6)
    v_pk_add_f32 v[144:145], v[144:145], v[146:147]
    s_waitcnt lgkmcnt(4)
    v_pk_add_f32 v[148:149], v[148:149], v[150:151]
    v_pk_add_f32 v[144:145], v[144:145], v[148:149]
    s_waitcnt lgkmcnt(2)
    v_pk_add_f32 v[152:153], v[152:153], v[154:155]
    s_waitcnt lgkmcnt(0)
    v_pk_add_f32 v[156:157], v[156:157], v[158:159]
    v_pk_add_f32 v[152:153], v[152:153], v[156:157]
    v_pk_add_f32 v[144:145], v[144:145], v[152:153]
    v_mov_b32 v6, v144
    v_mov_b32 v7, v145
    v_lshlrev_b32 v36, 16, v36
    v_lshlrev_b32 v37, 16, v37
    s_mov_b64 s[56:57], -1
    s_mov_b64 s[60:61], -1
    s_mov_b64 s[64:65], -1
    s_mov_b64 s[40:41], -1
L_ppoll:
    s_sleep 1
    s_mov_b64 exec, s[56:57]
    s_cbranch_execz L_pskip0
    buffer_load_dwordx4 v[96:99], v21, s[52:55], s69 offen offset:0 sc1
L_pskip0:
    s_mov_b64 exec, s[60:61]
    s_cbranch_execz L_pskip1
    buffer_load_dwordx4 v[100:103], v21, s[52:55], s69 offen offset:1024 sc1
L_pskip1:
    s_mov_b64 exec, s[64:65]
    s_cbranch_execz L_pskip2
    buffer_load_dwordx4 v[104:107], v22, s[52:55], s69 offen offset:0 sc1
L_pskip2:
    s_mov_b64 exec, s[40:41]
    s_cbranch_execz L_pskip3
    buffer_load_dwordx4 v[108:111], v22, s[52:55], s69 offen offset:1024 sc1
L_pskip3:
    s_mov_b64 exec, -1
    s_sub_u32 s77, s77, 1
    s_cbranch_scc1 L_end
    s_waitcnt vmcnt(0)
    v_xor_b32 v28, s48, v96
    v_xor_b32 v29, s48, v100
    v_xor_b32 v30, s48, v104
    v_xor_b32 v31, s48, v108
    v_bitop3_b32 v28, v28, v97, s49 bitop3:0xf6
    v_bitop3_b32 v29, v29, v101, s49 bitop3:0xf6
    v_bitop3_b32 v30, v30, v105, s49 bitop3:0xf6
    v_bitop3_b32 v31, v31, v109, s49 bitop3:0xf6
    v_bitop3_b32 v28, v28, v98, s50 bitop3:0xf6
    v_bitop3_b32 v29, v29, v102, s50 bitop3:0xf6
    v_bitop3_b32 v30, v30, v106, s50 bitop3:0xf6
    v_bitop3_b32 v31, v31, v110, s50 bitop3:0xf6
    v_bitop3_b32 v28, v28, v99, s51 bitop3:0xf6
    v_bitop3_b32 v29, v29, v103, s51 bitop3:0xf6
    v_bitop3_b32 v30, v30, v107, s51 bitop3:0xf6
    v_bitop3_b32 v31, v31, v111, s51 bitop3:0xf6
    v_and_b32 v28, 0xff, v28
    v_and_b32 v29, 0xff, v29
    v_and_b32 v30, 0xff, v30
    v_and_b32 v31, 0xff, v31
    v_cmp_ne_u32 s[56:57], 0, v28
    v_cmp_ne_u32 s[60:61], 0, v29
    v_cmp_ne_u32 s[64:65], 0, v30
    v_cmp_ne_u32 s[40:41], 0, v31
    s_or_b64 vcc, s[56:57], s[60:61]
    s_or_b64 s[100:101], s[64:65], s[40:41]
    s_or_b64 vcc, vcc, s[100:101]
    s_cbranch_scc1 L_ppoll
    v_permlane16_swap_b32 v96, v97
    v_permlane16_swap_b32 v98, v99
    v_permlane16_swap_b32 v100, v101
    v_permlane16_swap_b32 v102, v103
    v_permlane16_swap_b32 v104, v105
    v_permlane16_swap_b32 v106, v107
    v_permlane16_swap_b32 v108, v109
    v_permlane16_swap_b32 v110, v111
    v_add_f32 v96, v96, v97
    v_add_f32 v98, v98, v99
    v_add_f32 v100, v100, v101
    v_add_f32 v102, v102, v103
    v_add_f32 v104, v104, v105
    v_add_f32 v106, v106, v107
    v_add_f32 v108, v108, v109
    v_add_f32 v110, v110, v111
    v_permlane32_swap_b32 v96, v98
    v_permlane32_swap_b32 v100, v102
    v_permlane32_swap_b32 v104, v106
    v_permlane32_swap_b32 v108, v110
    v_add_f32 v96, v96, v98
    v_add_f32 v100, v100, v102
    v_add_f32 v104, v104, v106
    v_add_f32 v108, v108, v110
    v_add_f32_dpp v24, v96, v96 row_ror:8 row_mask:0xf bank_mask:0x3
    s_nop 1
    v_add_f32_dpp v24, v100, v100 row_ror:8 row_mask:0xf bank_mask:0xc
    v_add_f32_dpp v25, v104, v104 row_ror:8 row_mask:0xf bank_mask:0x3
    s_nop 1
    v_add_f32_dpp v25, v108, v108 row_ror:8 row_mask:0xf bank_mask:0xc
    v_pk_add_f32 v[24:25], v[24:25], v[36:37]
    v_cvt_pk_bf16_f32 v23, v24, v25
    ds_write_b16 v17, v23 offset:10240
    ds_write_b16_d16_hi v17, v23 offset:11264
    ds_read_b128 v[144:147], v5 offset:0
    ds_read_b128 v[148:151], v5 offset:64
    v_lshlrev_b32 v28, 16, v23
    v_and_b32 v30, 0xffff0000, v23
    v_mul_f32 v29, v28, v28
    v_mul_f32 v31, v30, v30
    s_nop 0
    v_permlane16_swap_b32 v28, v29
    v_permlane16_swap_b32 v30, v31
    v_add_f32 v28, v28, v29
    v_add_f32 v30, v30, v31
    s_nop 1
    v_permlane32_swap_b32 v28, v30
    v_add_f32 v28, v28, v30
    s_waitcnt lgkmcnt(1)
    v_mfma_f32_16x16x32_bf16 v[112:115], v[144:147], v[48:51], 0
    v_add_f32_dpp v28, v28, v28 quad_perm:[1,0,3,2] row_mask:0xf bank_mask:0xf
    v_mfma_f32_16x16x32_bf16 v[116:119], v[144:147], v[52:55], 0
    s_nop 0
    v_add_f32_dpp v28, v28, v28 quad_perm:[2,3,0,1] row_mask:0xf bank_mask:0xf
    v_mfma_f32_16x16x32_bf16 v[120:123], v[144:147], v[56:59], 0
    s_nop 0
    v_add_f32_dpp v28, v28, v28 row_ror:4 row_mask:0xf bank_mask:0xf
    v_mfma_f32_16x16x32_bf16 v[124:127], v[144:147], v[60:63], 0
    s_nop 0
    v_add_f32_dpp v28, v28, v28 row_ror:8 row_mask:0xf bank_mask:0xf
    s_waitcnt lgkmcnt(0)
    v_mfma_f32_16x16x32_bf16 v[112:115], v[148:151], v[64:67], v[112:115]
    v_mfma_f32_16x16x32_bf16 v[116:119], v[148:151], v[68:71], v[116:119]
    ds_write_b32 v38, v28 offset:7168
    v_mfma_f32_16x16x32_bf16 v[120:123], v[148:151], v[72:75], v[120:123]
    v_mfma_f32_16x16x32_bf16 v[124:127], v[148:151], v[76:79], v[124:127]
    s_nop 4
    v_mov_b32_dpp v112, v116 quad_perm:[0,1,2,3] row_mask:0x2 bank_mask:0xf
    v_mov_b32_dpp v113, v117 quad_perm:[0,1,2,3] row_mask:0x2 bank_mask:0xf
    s_nop 0
    v_mov_b32_dpp v112, v120 quad_perm:[0,1,2,3] row_mask:0x4 bank_mask:0xf
    v_mov_b32_dpp v113, v121 quad_perm:[0,1,2,3] row_mask:0x4 bank_mask:0xf
    s_nop 0
    v_mov_b32_dpp v112, v124 quad_perm:[0,1,2,3] row_mask:0x8 bank_mask:0xf
    v_mov_b32_dpp v113, v125 quad_perm:[0,1,2,3] row_mask:0x8 bank_mask:0xf
    ds_write_b64 v13, v[112:113] offset:12288
    s_waitcnt lgkmcnt(0)
    s_barrier
    ds_read_b64 v[28:29], v39 offset:7168
    ds_read2st64_b32 v[144:145], v15 offset0:0 offset1:1
    ds_read2st64_b32 v[146:147], v15 offset0:2 offset1:3
    ds_read2st64_b32 v[148:149], v15 offset0:4 offset1:5
    ds_read2st64_b32 v[150:151], v15 offset0:6 offset1:7
    ds_read2st64_b32 v[152:153], v15 offset0:8 offset1:9
    ds_read2st64_b32 v[154:155], v15 offset0:10 offset1:11
    ds_read2st64_b32 v[156:157], v15 offset0:12 offset1:13
    ds_read2st64_b32 v[158:159], v15 offset0:14 offset1:15
    s_waitcnt lgkmcnt(8)
    v_add_f32_dpp v28, v28, v28 quad_perm:[2,3,0,1] row_mask:0xf bank_mask:0xf
    v_add_f32_dpp v29, v29, v29 quad_perm:[2,3,0,1] row_mask:0xf bank_mask:0xf
    s_nop 0
    v_add_f32_dpp v28, v28, v28 row_ror:4 row_mask:0xf bank_mask:0xf
    v_add_f32_dpp v29, v29, v29 row_ror:4 row_mask:0xf bank_mask:0xf
    s_nop 0
    v_add_f32_dpp v28, v28, v28 row_ror:8 row_mask:0xf bank_mask:0xf
    v_add_f32_dpp v29, v29, v29 row_ror:8 row_mask:0xf bank_mask:0xf
    v_mul_f32 v28, 0x3b000000, v28
    v_mul_f32 v30, v28, v28
    s_waitcnt lgkmcnt(6)
    v_pk_add_f32 v[144:145], v[144:145], v[146:147]
    v_fma_f32 v30, v29, v34, -v30
    v_max_f32 v30, 0, v30
    s_waitcnt lgkmcnt(4)
    v_pk_add_f32 v[148:149], v[148:149], v[150:151]
    v_cvt_pk_bf16_f32 v30, v28, v30
    v_lshlrev_b32 v28, 16, v30
    v_pk_add_f32 v[144:145], v[144:145], v[148:149]
    v_and_b32 v30, 0xffff0000, v30
    v_add_f32 v30, 0x3727c5ac, v30
    s_waitcnt lgkmcnt(2)
    v_pk_add_f32 v[152:153], v[152:153], v[154:155]
    v_cvt_pk_bf16_f32 v30, v30, v30
    v_and_b32 v30, 0xffff0000, v30
    s_waitcnt lgkmcnt(0)
    v_pk_add_f32 v[156:157], v[156:157], v[158:159]
    v_sqrt_f32 v30, v30
    v_mov_b32 v29, v28
    v_pk_add_f32 v[152:153], v[152:153], v[156:157]
    v_cvt_pk_bf16_f32 v30, v30, v30
    v_and_b32 v30, 0xffff0000, v30
    v_pk_add_f32 v[144:145], v[144:145], v[152:153]
    v_rcp_f32 v30, v30
    v_pk_fma_f32 v[144:145], v[28:29], v[6:7], v[144:145] neg_lo:[1,0,0] neg_hi:[1,0,0]
    v_mul_f32 v18, v144, v30
    v_mul_f32 v19, v145, v30
    v_mul_f32 v20, 0xbfb8aa3b, v18
    v_exp_f32 v20, v20
    v_mul_f32 v18, v18, v19
    v_add_f32 v20, 1.0, v20
    v_rcp_f32 v20, v20
    s_nop 0
    v_mul_f32 v18, v18, v20
    v_cvt_pk_bf16_f32 v18, v18, v18
    ds_write_b16 v16, v18
    ds_read_b128 v[144:147], v9
    ds_read_b128 v[148:151], v10
    ds_read_b128 v[152:155], v11
    ds_read_b128 v[156:159], v12
    s_waitcnt lgkmcnt(3)
    v_mfma_f32_16x16x32_bf16 v[28:31], v[80:83], v[144:147], 0
    s_waitcnt lgkmcnt(2)
    v_mfma_f32_16x16x32_bf16 v[28:31], v[84:87], v[148:151], v[28:31]
    s_waitcnt lgkmcnt(1)
    v_mfma_f32_16x16x32_bf16 v[28:31], v[88:91], v[152:155], v[28:31]
    s_waitcnt lgkmcnt(0)
    v_mfma_f32_16x16x32_bf16 v[28:31], v[92:95], v[156:159], v[28:31]
    s_nop 7
    v_bfi_b32 v28, v4, s48, v28
    v_bfi_b32 v29, v4, s49, v29
    v_bfi_b32 v30, v4, s50, v30
    v_bfi_b32 v31, v4, s51, v31
    s_mov_b32 exec_lo, 0x00ff00ff
    s_mov_b32 exec_hi, 0x00ff00ff
    buffer_store_dwordx4 v[28:31], v14, s[52:55], s68 offen sc1
    s_mov_b64 exec, -1
L_exit:
    s_nop 0
L_end:
    s_endpgm
L_svc:
    s_nop 0
    s_setprio 3
    v_lshrrev_b32 v46, 5, v1
    v_and_b32 v47, 31, v1
    v_lshlrev_b32 v46, 10, v46
    v_lshl_add_u32 v43, v47, 4, v46
    s_lshl_b32 s100, s78, 7
    v_lshl_add_u32 v44, v47, 2, v46
    v_add_u32 v44, s100, v44
    v_lshlrev_b32 v3, 13, v41
    v_lshl_add_u32 v3, v42, 4, v3
    s_lshl_b32 s101, s72, 8
    s_lshl_b32 s76, s78, 19
    s_add_u32 s101, s101, s76
    s_sub_u32 s42, 0x400000, s101
    s_mov_b32 s43, 0x20000
    s_lshl_b32 s77, s72, 3
    v_mov_b32 v37, s77
    v_mov_b32 v39, 0
    ds_write_b32 v39, v39 offset:6528
    s_waitcnt lgkmcnt(0)
    global_load_dwordx4 v[144:147], v43, s[4:5]
    s_add_u32 s40, s10, s101
    s_addc_u32 s41, s11, 0
    global_load_dwordx4 v[148:151], v43, s[4:5] offset:512
    s_or_b32 s70, s70, 1
    v_mov_b32 v38, s70
    global_load_dword v152, v44, s[4:5]
    s_mov_b32 m0, 16384
    s_nop 0
    buffer_load_dwordx4 v3, s[40:43], 0 offen nt lds
    s_mov_b32 m0, 17408
    s_mov_b32 s76, 32768
    buffer_load_dwordx4 v3, s[40:43], s76 offen nt lds
    s_mov_b32 m0, 18432
    s_mov_b32 s76, 65536
    buffer_load_dwordx4 v3, s[40:43], s76 offen nt lds
    s_mov_b32 m0, 19456
    s_mov_b32 s76, 98304
    buffer_load_dwordx4 v3, s[40:43], s76 offen nt lds
    s_mov_b32 m0, 20480
    s_mov_b32 s76, 131072
    buffer_load_dwordx4 v3, s[40:43], s76 offen nt lds
    s_mov_b32 m0, 21504
    s_mov_b32 s76, 163840
    buffer_load_dwordx4 v3, s[40:43], s76 offen nt lds
    s_mov_b32 m0, 22528
    s_mov_b32 s76, 196608
    buffer_load_dwordx4 v3, s[40:43], s76 offen nt lds
    s_mov_b32 m0, 23552
    s_mov_b32 s76, 229376
    buffer_load_dwordx4 v3, s[40:43], s76 offen nt lds
    s_mov_b32 m0, 24576
    s_mov_b32 s76, 262144
    buffer_load_dwordx4 v3, s[40:43], s76 offen nt lds
    s_mov_b32 m0, 25600
    s_mov_b32 s76, 294912
    buffer_load_dwordx4 v3, s[40:43], s76 offen nt lds
    s_mov_b32 m0, 26624
    s_mov_b32 s76, 327680
    buffer_load_dwordx4 v3, s[40:43], s76 offen nt lds
    s_mov_b32 m0, 27648
    s_mov_b32 s76, 360448
    buffer_load_dwordx4 v3, s[40:43], s76 offen nt lds
    s_mov_b32 m0, 28672
    s_mov_b32 s76, 393216
    buffer_load_dwordx4 v3, s[40:43], s76 offen nt lds
    s_mov_b32 m0, 29696
    s_mov_b32 s76, 425984
    buffer_load_dwordx4 v3, s[40:43], s76 offen nt lds
    s_mov_b32 m0, 30720
    s_mov_b32 s76, 458752
    buffer_load_dwordx4 v3, s[40:43], s76 offen nt lds
    s_mov_b32 m0, 31744
    s_mov_b32 s76, 491520
    buffer_load_dwordx4 v3, s[40:43], s76 offen nt lds
    s_mov_b64 exec, 1
    global_atomic_cmpswap v36, v37, v[38:39], s[26:27] sc0 sc1
    s_mov_b64 exec, -1
    s_barrier
    s_getreg_b32 s61, hwreg(HW_REG_XCC_ID, 0, 4)
    s_add_u32 s61, s61, 1
    s_mov_b32 s101, 0x3f803f80
    v_mov_b32 v27, 0x3b000000
    s_mov_b32 s52, s28
    s_mov_b32 s53, s29
    s_mov_b32 s54, 4194304
    s_mov_b32 s55, 0x20000
    v_lshlrev_b32 v44, 2, v1
    ds_write_b32 v44, v39 offset:6144
    v_and_b32 v45, 1, v1
    v_lshlrev_b32 v46, 7, v45
    v_lshl_add_u32 v46, v41, 4, v46
    v_add_u32 v46, 6912, v46
    v_lshrrev_b32 v25, 1, v42
    v_mov_b32 v24, 6144
    v_cmp_eq_u32 vcc, 0, v25
    s_nop 1
    v_cndmask_b32 v5, v24, v46, vcc
    v_cmp_eq_u32 vcc, 1, v25
    s_nop 1
    v_cndmask_b32 v6, v24, v46, vcc
    v_cmp_eq_u32 vcc, 2, v25
    s_nop 1
    v_cndmask_b32 v7, v24, v46, vcc
    v_cmp_eq_u32 vcc, 3, v25
    s_nop 1
    v_cndmask_b32 v8, v24, v46, vcc
    v_cmp_eq_u32 vcc, 4, v25
    s_nop 1
    v_cndmask_b32 v9, v24, v46, vcc
    v_cmp_eq_u32 vcc, 5, v25
    s_nop 1
    v_cndmask_b32 v10, v24, v46, vcc
    v_cmp_eq_u32 vcc, 6, v25
    s_nop 1
    v_cndmask_b32 v11, v24, v46, vcc
    v_cmp_eq_u32 vcc, 7, v25
    s_nop 1
    v_cndmask_b32 v12, v24, v46, vcc
    v_lshrrev_b32 v47, 2, v42
    v_lshl_add_u32 v47, v41, 3, v47
    v_lshlrev_b32 v47, 8, v47
    v_and_b32 v43, 3, v42
    v_lshl_add_u32 v47, v43, 3, v47
    v_lshlrev_b32 v4, 12, v45
    v_lshl_add_u32 v4, v25, 6, v4
    v_lshl_add_u32 v4, v41, 4, v4
    v_lshlrev_b32 v45, 4, v1
    v_add_u32 v43, 4096, v45
    s_and_b32 s100, s72, 7
    s_lshl_b32 s100, s100, 16
    s_lshr_b32 s68, s72, 3
    s_lshl_b32 s68, s68, 13
    s_add_u32 s100, s100, s68
    s_lshl_b32 s68, s78, 9
    s_add_u32 s68, s68, s100
    s_add_u32 s68, s68, 2621440
    s_lshl_b32 s69, s73, 12
    s_add_u32 s69, s69, s100
    s_add_u32 s69, s69, 2621440
    s_waitcnt vmcnt(18)
    v_dot2_f32_bf16 v18, v144, s101, 0
    v_dot2_f32_bf16 v19, v144, v144, 0
    v_dot2_f32_bf16 v18, v145, s101, v18
    v_dot2_f32_bf16 v19, v145, v145, v19
    v_dot2_f32_bf16 v18, v146, s101, v18
    v_dot2_f32_bf16 v19, v146, v146, v19
    v_dot2_f32_bf16 v18, v147, s101, v18
    v_dot2_f32_bf16 v19, v147, v147, v19
    v_dot2_f32_bf16 v18, v148, s101, v18
    v_dot2_f32_bf16 v19, v148, v148, v19
    v_dot2_f32_bf16 v18, v149, s101, v18
    v_dot2_f32_bf16 v19, v149, v149, v19
    v_dot2_f32_bf16 v18, v150, s101, v18
    v_dot2_f32_bf16 v19, v150, v150, v19
    v_dot2_f32_bf16 v18, v151, s101, v18
    v_dot2_f32_bf16 v19, v151, v151, v19
    s_waitcnt vmcnt(17)
    v_lshlrev_b32 v154, 16, v152
    v_and_b32 v155, 0xffff0000, v152
    v_add_f32_dpp v18, v18, v18 quad_perm:[1,0,3,2] row_mask:0xf bank_mask:0xf
    v_add_f32_dpp v19, v19, v19 quad_perm:[1,0,3,2] row_mask:0xf bank_mask:0xf
    s_nop 0
    v_add_f32_dpp v18, v18, v18 quad_perm:[2,3,0,1] row_mask:0xf bank_mask:0xf
    v_add_f32_dpp v19, v19, v19 quad_perm:[2,3,0,1] row_mask:0xf bank_mask:0xf
    s_nop 0
    v_add_f32_dpp v18, v18, v18 row_ror:4 row_mask:0xf bank_mask:0xf
    v_add_f32_dpp v19, v19, v19 row_ror:4 row_mask:0xf bank_mask:0xf
    s_nop 0
    v_add_f32_dpp v18, v18, v18 row_ror:8 row_mask:0xf bank_mask:0xf
    v_add_f32_dpp v19, v19, v19 row_ror:8 row_mask:0xf bank_mask:0xf
    v_mov_b32 v20, v18
    v_mov_b32 v21, v19
    s_nop 0
    v_permlane16_swap_b32 v18, v20
    v_permlane16_swap_b32 v19, v21
    v_add_f32 v18, v18, v20
    v_add_f32 v19, v19, v21
    v_mul_f32 v18, 0x3b000000, v18
    v_mul_f32 v26, v18, v18
    v_fma_f32 v26, v19, v27, -v26
    v_max_f32 v26, 0, v26
    v_cvt_pk_bf16_f32 v20, v18, v18
    v_and_b32 v20, 0xffff0000, v20
    v_cvt_pk_bf16_f32 v26, v26, v26
    v_and_b32 v26, 0xffff0000, v26
    v_mov_b32 v21, v20
    v_add_f32 v26, 0x3727c5ac, v26
    v_cvt_pk_bf16_f32 v26, v26, v26
    v_and_b32 v26, 0xffff0000, v26
    v_sqrt_f32 v26, v26
    s_nop 0
    v_cvt_pk_bf16_f32 v26, v26, v26
    v_and_b32 v26, 0xffff0000, v26
    v_rcp_f32 v22, v26
    s_nop 0
    v_mov_b32 v23, v22
    v_pk_add_f32 v[154:155], v[154:155], v[20:21] neg_lo:[0,1] neg_hi:[0,1]
    v_cvt_pk_bf16_f32 v155, v154, v155
    v_lshlrev_b32 v154, 16, v155
    v_and_b32 v155, 0xffff0000, v155
    v_pk_mul_f32 v[154:155], v[154:155], v[22:23]
    v_cvt_pk_bf16_f32 v152, v154, v155
    ds_write_b32 v44, v152 offset:6912
    s_waitcnt lgkmcnt(0)
    ds_read_b128 v[80:83], v5 offset:0
    ds_read_b128 v[84:87], v6 offset:0
    ds_read_b128 v[88:91], v7 offset:0
    ds_read_b128 v[92:95], v8 offset:0
    ds_read_b128 v[96:99], v9 offset:0
    ds_read_b128 v[100:103], v10 offset:0
    ds_read_b128 v[104:107], v11 offset:0
    ds_read_b128 v[108:111], v12 offset:0
    s_waitcnt lgkmcnt(0)
    ds_read_b128 v[112:115], v5 offset:64
    ds_read_b128 v[116:119], v6 offset:64
    ds_read_b128 v[120:123], v7 offset:64
    ds_read_b128 v[124:127], v8 offset:64
    ds_read_b128 v[128:131], v9 offset:64
    ds_read_b128 v[132:135], v10 offset:64
    ds_read_b128 v[136:139], v11 offset:64
    ds_read_b128 v[140:143], v12 offset:64
    s_waitcnt vmcnt(9)
    ds_read_b64_tr_b16 v[48:49], v47 offset:16384
    ds_read_b64_tr_b16 v[50:51], v47 offset:17408
    ds_read_b64_tr_b16 v[52:53], v47 offset:16416
    ds_read_b64_tr_b16 v[54:55], v47 offset:17440
    ds_read_b64_tr_b16 v[56:57], v47 offset:16448
    ds_read_b64_tr_b16 v[58:59], v47 offset:17472
    ds_read_b64_tr_b16 v[60:61], v47 offset:16480
    ds_read_b64_tr_b16 v[62:63], v47 offset:17504
    s_waitcnt lgkmcnt(0)
    ds_read_b64_tr_b16 v[64:65], v47 offset:16512
    ds_read_b64_tr_b16 v[66:67], v47 offset:17536
    ds_read_b64_tr_b16 v[68:69], v47 offset:16544
    ds_read_b64_tr_b16 v[70:71], v47 offset:17568
    ds_read_b64_tr_b16 v[72:73], v47 offset:16576
    ds_read_b64_tr_b16 v[74:75], v47 offset:17600
    ds_read_b64_tr_b16 v[76:77], v47 offset:16608
    ds_read_b64_tr_b16 v[78:79], v47 offset:17632
    s_waitcnt lgkmcnt(0)
    v_mfma_f32_16x16x32_bf16 v[28:31], v[48:51], v[80:83], 0
    v_mfma_f32_16x16x32_bf16 v[28:31], v[52:55], v[84:87], v[28:31]
    v_mfma_f32_16x16x32_bf16 v[28:31], v[56:59], v[88:91], v[28:31]
    v_mfma_f32_16x16x32_bf16 v[28:31], v[60:63], v[92:95], v[28:31]
    v_mfma_f32_16x16x32_bf16 v[28:31], v[64:67], v[96:99], v[28:31]
    v_mfma_f32_16x16x32_bf16 v[28:31], v[68:71], v[100:103], v[28:31]
    v_mfma_f32_16x16x32_bf16 v[28:31], v[72:75], v[104:107], v[28:31]
    v_mfma_f32_16x16x32_bf16 v[28:31], v[76:79], v[108:111], v[28:31]
    s_waitcnt vmcnt(1)
    ds_read_b64_tr_b16 v[48:49], v47 offset:24576
    ds_read_b64_tr_b16 v[50:51], v47 offset:25600
    ds_read_b64_tr_b16 v[52:53], v47 offset:24608
    ds_read_b64_tr_b16 v[54:55], v47 offset:25632
    ds_read_b64_tr_b16 v[56:57], v47 offset:24640
    ds_read_b64_tr_b16 v[58:59], v47 offset:25664
    ds_read_b64_tr_b16 v[60:61], v47 offset:24672
    ds_read_b64_tr_b16 v[62:63], v47 offset:25696
    s_waitcnt lgkmcnt(0)
    ds_read_b64_tr_b16 v[64:65], v47 offset:24704
    ds_read_b64_tr_b16 v[66:67], v47 offset:25728
    ds_read_b64_tr_b16 v[68:69], v47 offset:24736
    ds_read_b64_tr_b16 v[70:71], v47 offset:25760
    ds_read_b64_tr_b16 v[72:73], v47 offset:24768
    ds_read_b64_tr_b16 v[74:75], v47 offset:25792
    ds_read_b64_tr_b16 v[76:77], v47 offset:24800
    ds_read_b64_tr_b16 v[78:79], v47 offset:25824
    s_waitcnt lgkmcnt(0)
    v_mfma_f32_16x16x32_bf16 v[28:31], v[48:51], v[112:115], v[28:31]
    v_mfma_f32_16x16x32_bf16 v[28:31], v[52:55], v[116:119], v[28:31]
    v_mfma_f32_16x16x32_bf16 v[28:31], v[56:59], v[120:123], v[28:31]
    v_mfma_f32_16x16x32_bf16 v[28:31], v[60:63], v[124:127], v[28:31]
    v_mfma_f32_16x16x32_bf16 v[28:31], v[64:67], v[128:131], v[28:31]
    v_mfma_f32_16x16x32_bf16 v[28:31], v[68:71], v[132:135], v[28:31]
    v_mfma_f32_16x16x32_bf16 v[28:31], v[72:75], v[136:139], v[28:31]
    v_mfma_f32_16x16x32_bf16 v[28:31], v[76:79], v[140:143], v[28:31]
    s_waitcnt vmcnt(0)
    v_readfirstlane_b32 s100, v36
    s_cmp_eq_u32 s100, 0
    s_cselect_b32 s79, s70, s100
    s_add_u32 s71, s79, s61
    v_mov_b32 v34, 0xff
    v_mov_b32 v35, 0x80
    s_mov_b32 s101, s71
    s_lshr_b32 s32, s101, 8
    s_lshr_b32 s33, s101, 16
    s_lshr_b32 s34, s101, 24
    v_bfi_b32 v28, v34, s101, v28
    v_bfi_b32 v29, v34, s32, v29
    v_bfi_b32 v30, v34, s33, v30
    v_bfi_b32 v31, v34, s34, v31
    buffer_store_dwordx4 v[28:31], v4, s[52:55], s68 offen
    s_sub_u32 s68, s68, 2097152
    s_mov_b32 s77, 400000
L_qpoll:
    s_cmp_lg_u32 s77, 399952
    s_cbranch_scc1 L_qnost
    s_mov_b32 s101, s79
    s_lshr_b32 s32, s101, 8
    s_lshr_b32 s33, s101, 16
    s_lshr_b32 s34, s101, 24
    v_bfi_b32 v28, v34, s101, v28
    v_bfi_b32 v29, v34, s32, v29
    v_bfi_b32 v30, v34, s33, v30
    v_bfi_b32 v31, v34, s34, v31
    buffer_store_dwordx4 v[28:31], v4, s[52:55], s68 offen sc1
L_qnost:
    s_cmp_lt_u32 s77, 399952
    s_cselect_b32 s100, s77, 0
    s_bitcmp1_b32 s100, 0
    s_cselect_b32 s100, 2097152, 0
    s_cselect_b32 s101, s79, s71
    s_sub_u32 s100, s69, s100
    buffer_load_dwordx4 v[48:51], v45, s[52:55], s100 offen offset:0 sc1
    buffer_load_dwordx4 v[52:55], v45, s[52:55], s100 offen offset:1024 sc1
    buffer_load_dwordx4 v[56:59], v45, s[52:55], s100 offen offset:2048 sc1
    buffer_load_dwordx4 v[60:63], v45, s[52:55], s100 offen offset:3072 sc1
    s_lshr_b32 s32, s101, 8
    s_lshr_b32 s33, s101, 16
    s_lshr_b32 s34, s101, 24
    s_sub_u32 s77, s77, 1
    s_cbranch_scc1 L_end
    s_waitcnt vmcnt(0)
    v_xor_b32 v20, s101, v48
    v_bitop3_b32 v20, v20, v49, s32 bitop3:0xf6
    v_bitop3_b32 v20, v20, v50, s33 bitop3:0xf6
    v_bitop3_b32 v20, v20, v51, s34 bitop3:0xf6
    v_bitop3_b32 v20, v20, v52, s101 bitop3:0xf6
    v_bitop3_b32 v20, v20, v53, s32 bitop3:0xf6
    v_bitop3_b32 v20, v20, v54, s33 bitop3:0xf6
    v_bitop3_b32 v20, v20, v55, s34 bitop3:0xf6
    v_bitop3_b32 v20, v20, v56, s101 bitop3:0xf6
    v_bitop3_b32 v20, v20, v57, s32 bitop3:0xf6
    v_bitop3_b32 v20, v20, v58, s33 bitop3:0xf6
    v_bitop3_b32 v20, v20, v59, s34 bitop3:0xf6
    v_bitop3_b32 v20, v20, v60, s101 bitop3:0xf6
    v_bitop3_b32 v20, v20, v61, s32 bitop3:0xf6
    v_bitop3_b32 v20, v20, v62, s33 bitop3:0xf6
    v_bitop3_b32 v20, v20, v63, s34 bitop3:0xf6
    v_and_b32 v20, 0xff, v20
    v_cmp_ne_u32 vcc, 0, v20
    s_cbranch_vccnz L_qpoll
    v_bfi_b32 v48, v34, v35, v48
    v_bfi_b32 v49, v34, v35, v49
    v_bfi_b32 v50, v34, v35, v50
    v_bfi_b32 v51, v34, v35, v51
    v_bfi_b32 v52, v34, v35, v52
    v_bfi_b32 v53, v34, v35, v53
    v_bfi_b32 v54, v34, v35, v54
    v_bfi_b32 v55, v34, v35, v55
    v_bfi_b32 v56, v34, v35, v56
    v_bfi_b32 v57, v34, v35, v57
    v_bfi_b32 v58, v34, v35, v58
    v_bfi_b32 v59, v34, v35, v59
    v_bfi_b32 v60, v34, v35, v60
    v_bfi_b32 v61, v34, v35, v61
    v_bfi_b32 v62, v34, v35, v62
    v_bfi_b32 v63, v34, v35, v63
    v_pk_add_f32 v[48:49], v[48:49], v[52:53]
    v_pk_add_f32 v[50:51], v[50:51], v[54:55]
    v_pk_add_f32 v[56:57], v[56:57], v[60:61]
    v_pk_add_f32 v[58:59], v[58:59], v[62:63]
    v_pk_add_f32 v[48:49], v[48:49], v[56:57]
    v_pk_add_f32 v[50:51], v[50:51], v[58:59]
    s_nop 1
    v_permlane32_swap_b32 v48, v50
    v_permlane32_swap_b32 v49, v51
    v_pk_add_f32 v[48:49], v[48:49], v[50:51]
    v_cvt_pk_bf16_f32 v48, v48, v49
    v_and_b32 v44, 31, v1
    v_lshlrev_b32 v44, 3, v44
    v_lshrrev_b32 v43, 5, v1
    v_lshl_add_u32 v44, v43, 2, v44
    ds_write_b32 v44, v48 offset:6656
    v_mov_b32 v38, 1
    ds_write_b32 v39, v38 offset:6528
    s_setprio 0
    s_sub_u32 s63, s101, s71
    s_mov_b32 s30, 0x3fb8aa3b
    v_mov_b32 v4, 0xff
    s_sub_u32 s100, s2, 32
    s_cmp_lt_u32 s100, 96
    s_cbranch_scc1 L_exit8
    s_mov_b32 s77, 400000
L_gn8:
    global_load_dword v9, v39, s[26:27] sc1
    s_sub_u32 s77, s77, 1
    s_cbranch_scc1 L_end
    s_waitcnt vmcnt(0)
    v_readfirstlane_b32 s48, v9
    s_cmp_eq_u32 s48, 0
    s_cbranch_scc1 L_gn8
    s_lshr_b32 s49, s48, 8
    s_lshr_b32 s50, s48, 16
    s_lshr_b32 s51, s48, 24
    s_mov_b32 s77, 400000
    v_lshlrev_b32 v21, 4, v1
    v_add_u32 v19, 4096, v21
    s_cmp_lt_u32 s2, 32
    s_cbranch_scc1 L_fin8
    s_and_b32 s100, s2, 7
    s_bfe_u32 s101, s2, 0x40003
    s_lshl_b32 s69, s100, 4
    s_add_u32 s69, s69, s101
    s_lshl_b32 s69, s69, 12
    s_add_u32 s69, s69, 2097152
    s_lshl_b32 s68, s101, 11
    s_lshl_b32 s42, s100, 7
    s_add_u32 s68, s68, s42
    s_add_u32 s68, s68, 1114112
    s_lshr_b32 s101, s101, 3
    s_lshl_b32 s100, s100, 13
    s_lshl_b32 s43, s101, 8
    s_add_u32 s43, s43, s100
    s_add_u32 s43, s43, 3145728
    v_lshrrev_b32 v23, 3, v1
    v_lshlrev_b32 v22, 15, v23
    v_and_b32 v27, 7, v1
    v_lshl_add_u32 v22, v27, 4, v22
    v_lshlrev_b32 v23, 5, v23
    s_barrier
    buffer_load_dwordx4 v[48:51], v23, s[52:55], s43 offen offset:0 sc1
    buffer_load_dwordx4 v[52:55], v23, s[52:55], s43 offen offset:16 sc1
    buffer_load_dwordx4 v[56:59], v21, s[52:55], s69 offen offset:0 sc1
    buffer_load_dwordx4 v[60:63], v21, s[52:55], s69 offen offset:1024 sc1
    buffer_load_dwordx4 v[64:67], v21, s[52:55], s69 offen offset:2048 sc1
    buffer_load_dwordx4 v[68:71], v21, s[52:55], s69 offen offset:3072 sc1
    s_barrier
    s_mov_b32 s100, s43
    s_mov_b32 s101, s69
L_mlpoll:
    buffer_load_dwordx4 v[48:51], v23, s[52:55], s100 offen offset:0 sc1
    buffer_load_dwordx4 v[52:55], v23, s[52:55], s100 offen offset:16 sc1
    s_sub_u32 s77, s77, 1
    s_cbranch_scc1 L_end
    s_cmp_lt_u32 s77, 399936
    s_cselect_b32 s42, s77, 0
    s_bitcmp1_b32 s42, 0
    s_cselect_b32 s42, 2097152, 0
    s_sub_u32 s100, s43, s42
    s_waitcnt vmcnt(0)
    v_xor_b32 v14, s48, v50
    v_bitop3_b32 v14, v14, v51, s48 bitop3:0xf6
    v_bitop3_b32 v14, v14, v54, s48 bitop3:0xf6
    v_bitop3_b32 v14, v14, v55, s48 bitop3:0xf6
    v_cmp_ne_u32 vcc, 0, v14
    s_cbranch_vccnz L_mlpoll
    buffer_load_dwordx4 v[56:59], v21, s[52:55], s101 offen offset:0 sc1
    buffer_load_dwordx4 v[60:63], v21, s[52:55], s101 offen offset:1024 sc1
    buffer_load_dwordx4 v[64:67], v21, s[52:55], s101 offen offset:2048 sc1
    buffer_load_dwordx4 v[68:71], v21, s[52:55], s101 offen offset:3072 sc1
    v_max_f32 v20, v48, v52
    s_nop 1
    v_max_f32_dpp v20, v20, v20 row_ror:8 row_mask:0xf bank_mask:0xf
    v_mul_f32 v20, s30, v20
    v_fma_f32 v24, v48, s30, -v20
    v_fma_f32 v26, v52, s30, -v20
    v_exp_f32 v24, v24
    v_exp_f32 v26, v26
    v_mul_f32 v20, v24, v49
    v_fmac_f32 v20, v26, v53
    s_nop 1
    v_add_f32_dpp v20, v20, v20 row_ror:8 row_mask:0xf bank_mask:0xf
    v_rcp_f32 v20, v20
    s_nop 0
    v_mul_f32 v24, v24, v20
    v_mul_f32 v26, v26, v20
    v_mov_b32 v25, v24
    v_mov_b32 v27, v26
L_zpoll:
    buffer_load_dwordx4 v[72:75], v21, s[52:55], s101 offen offset:0 sc1
    buffer_load_dwordx4 v[76:79], v21, s[52:55], s101 offen offset:1024 sc1
    buffer_load_dwordx4 v[80:83], v21, s[52:55], s101 offen offset:2048 sc1
    buffer_load_dwordx4 v[84:87], v21, s[52:55], s101 offen offset:3072 sc1
    s_waitcnt vmcnt(7)
    v_xor_b32 v20, s48, v56
    v_bitop3_b32 v20, v20, v57, s49 bitop3:0xf6
    v_xor_b32 v18, s50, v58
    v_bitop3_b32 v18, v18, v59, s51 bitop3:0xf6
    s_waitcnt vmcnt(6)
    v_bitop3_b32 v20, v20, v60, s48 bitop3:0xf6
    v_bitop3_b32 v20, v20, v61, s49 bitop3:0xf6
    v_bitop3_b32 v18, v18, v62, s50 bitop3:0xf6
    v_bitop3_b32 v18, v18, v63, s51 bitop3:0xf6
    s_waitcnt vmcnt(5)
    v_bitop3_b32 v20, v20, v64, s48 bitop3:0xf6
    v_bitop3_b32 v20, v20, v65, s49 bitop3:0xf6
    v_bitop3_b32 v18, v18, v66, s50 bitop3:0xf6
    v_bitop3_b32 v18, v18, v67, s51 bitop3:0xf6
    s_waitcnt vmcnt(4)
    v_bitop3_b32 v20, v20, v68, s48 bitop3:0xf6
    v_bitop3_b32 v20, v20, v69, s49 bitop3:0xf6
    v_bitop3_b32 v18, v18, v70, s50 bitop3:0xf6
    v_bitop3_b32 v18, v18, v71, s51 bitop3:0xf6
    v_bitop3_b32 v20, v20, v18, v4 bitop3:0xa8
    v_cmp_ne_u32 vcc, 0, v20
    s_cbranch_vccz L_zok0
    buffer_load_dwordx4 v[56:59], v21, s[52:55], s101 offen offset:0 sc1
    buffer_load_dwordx4 v[60:63], v21, s[52:55], s101 offen offset:1024 sc1
    buffer_load_dwordx4 v[64:67], v21, s[52:55], s101 offen offset:2048 sc1
    buffer_load_dwordx4 v[68:71], v21, s[52:55], s101 offen offset:3072 sc1
    s_waitcnt vmcnt(7)
    v_xor_b32 v20, s48, v72
    v_bitop3_b32 v20, v20, v73, s49 bitop3:0xf6
    v_xor_b32 v18, s50, v74
    v_bitop3_b32 v18, v18, v75, s51 bitop3:0xf6
    s_waitcnt vmcnt(6)
    v_bitop3_b32 v20, v20, v76, s48 bitop3:0xf6
    v_bitop3_b32 v20, v20, v77, s49 bitop3:0xf6
    v_bitop3_b32 v18, v18, v78, s50 bitop3:0xf6
    v_bitop3_b32 v18, v18, v79, s51 bitop3:0xf6
    s_waitcnt vmcnt(5)
    v_bitop3_b32 v20, v20, v80, s48 bitop3:0xf6
    v_bitop3_b32 v20, v20, v81, s49 bitop3:0xf6
    v_bitop3_b32 v18, v18, v82, s50 bitop3:0xf6
    v_bitop3_b32 v18, v18, v83, s51 bitop3:0xf6
    s_waitcnt vmcnt(4)
    v_bitop3_b32 v20, v20, v84, s48 bitop3:0xf6
    v_bitop3_b32 v20, v20, v85, s49 bitop3:0xf6
    v_bitop3_b32 v18, v18, v86, s50 bitop3:0xf6
    v_bitop3_b32 v18, v18, v87, s51 bitop3:0xf6
    v_bitop3_b32 v20, v20, v18, v4 bitop3:0xa8
    v_cmp_ne_u32 vcc, 0, v20
    s_cbranch_vccz L_zok1
    s_sub_u32 s77, s77, 1
    s_cbranch_scc1 L_end
    s_cmp_lt_u32 s77, 399936
    s_cselect_b32 s42, s77, 0
    s_bitcmp1_b32 s42, 0
    s_cselect_b32 s42, 2097152, 0
    s_sub_u32 s101, s69, s42
    s_branch L_zpoll
L_zok1:
    v_pk_mul_f32 v[28:29], v[24:25], v[72:73]
    v_pk_mul_f32 v[30:31], v[24:25], v[74:75]
    v_pk_fma_f32 v[28:29], v[26:27], v[76:77], v[28:29]
    v_pk_fma_f32 v[30:31], v[26:27], v[78:79], v[30:31]
    v_pk_mul_f32 v[32:33], v[24:25], v[80:81]
    v_pk_mul_f32 v[34:35], v[24:25], v[82:83]
    v_pk_fma_f32 v[32:33], v[26:27], v[84:85], v[32:33]
    v_pk_fma_f32 v[34:35], v[26:27], v[86:87], v[34:35]
    s_branch L_zok
L_zok0:
    v_pk_mul_f32 v[28:29], v[24:25], v[56:57]
    v_pk_mul_f32 v[30:31], v[24:25], v[58:59]
    v_pk_fma_f32 v[28:29], v[26:27], v[60:61], v[28:29]
    v_pk_fma_f32 v[30:31], v[26:27], v[62:63], v[30:31]
    v_pk_mul_f32 v[32:33], v[24:25], v[64:65]
    v_pk_mul_f32 v[34:35], v[24:25], v[66:67]
    v_pk_fma_f32 v[32:33], v[26:27], v[68:69], v[32:33]
    v_pk_fma_f32 v[34:35], v[26:27], v[70:71], v[34:35]
L_zok:
    s_nop 0
    v_permlane16_swap_b32 v28, v29
    v_permlane16_swap_b32 v30, v31
    v_permlane16_swap_b32 v32, v33
    v_permlane16_swap_b32 v34, v35
    v_add_f32 v28, v28, v29
    v_add_f32 v30, v30, v31
    v_add_f32 v32, v32, v33
    v_add_f32 v34, v34, v35
    v_permlane32_swap_b32 v28, v30
    s_nop 0
    v_permlane32_swap_b32 v32, v34
    v_add_f32 v28, v28, v30
    v_add_f32 v32, v32, v34
    s_nop 0
    v_add_f32_dpp v28, v28, v28 row_ror:8 row_mask:0xf bank_mask:0xf
    v_add_f32_dpp v32, v32, v32 row_ror:8 row_mask:0xf bank_mask:0xf
    v_mov_b32 v29, v28
    v_mov_b32 v33, v32
    s_nop 0
    v_permlane16_swap_b32 v28, v29
    v_permlane16_swap_b32 v32, v33
    v_mov_b32 v30, v28
    v_mov_b32 v31, v29
    v_mov_b32 v34, v32
    v_mov_b32 v35, v33
    v_permlane32_swap_b32 v28, v30
    v_permlane32_swap_b32 v29, v31
    v_permlane32_swap_b32 v32, v34
    v_permlane32_swap_b32 v33, v35
    v_bfi_b32 v28, v4, s48, v28
    v_bfi_b32 v29, v4, s49, v29
    v_bfi_b32 v30, v4, s50, v30
    v_bfi_b32 v31, v4, s51, v31
    buffer_store_dwordx4 v[28:31], v22, s[52:55], s68 offen offset:0 sc1
    v_bfi_b32 v32, v4, s48, v32
    v_bfi_b32 v33, v4, s49, v33
    v_bfi_b32 v34, v4, s50, v34
    v_bfi_b32 v35, v4, s51, v35
    buffer_store_dwordx4 v[32:35], v22, s[52:55], s68 offen offset:1024 sc1
    s_branch L_exit8
L_fin8:
    s_nop 0
    s_cmp_lg_u32 s63, 0
    s_cbranch_scc1 L_nomark
    s_and_b32 s100, s2, 7
    s_lshl_b32 s100, s100, 13
    s_lshr_b32 s101, s2, 3
    s_lshl_b32 s101, s101, 2
    s_add_u32 s100, s100, s101
    s_add_u32 s100, s100, 3146240
    s_add_u32 s101, s48, s61
    v_mov_b32 v38, s101
    s_mov_b64 exec, 1
    buffer_store_dword v38, v39, s[52:55], s100 offen
    s_mov_b64 exec, -1
L_nomark:
    v_lshrrev_b32 v27, 5, v1
    v_and_b32 v26, 31, v1
    v_lshlrev_b32 v26, 4, v26
    v_lshl_add_u32 v17, v27, 10, v26
    global_load_dwordx4 v[136:139], v26, s[16:17] offset:0
    global_load_dwordx4 v[140:143], v26, s[16:17] offset:512
    s_mul_i32 s100, s2, 6144
    s_add_u32 s100, s100, 1376256
    s_add_u32 s44, s28, s100
    s_addc_u32 s45, s29, 0
    s_mov_b32 s46, 5504
    s_mov_b32 s47, 0x20000
    v_bfe_u32 v16, v1, 2, 1
    v_and_b32 v15, 3, v1
    v_lshlrev_b32 v15, 3, v15
    v_lshl_add_u32 v15, v41, 1, v15
    v_lshl_add_u32 v15, v16, 10, v15
    s_lshl_b32 s100, s2, 5
    v_add_u32 v15, s100, v15
    s_waitcnt vmcnt(0)
    s_barrier
    s_barrier
    s_barrier
    s_barrier
    ds_read_b128 v[104:107], v17 offset:10240
    ds_read_b128 v[108:111], v17 offset:10752
    ds_read_u16 v25, v15 offset:10240
    s_mov_b32 s101, 0x3f803f80
    v_mov_b32 v33, 0x3b000000
    s_waitcnt lgkmcnt(0)
    v_dot2_f32_bf16 v18, v104, s101, 0
    v_dot2_f32_bf16 v14, v104, v104, 0
    v_dot2_f32_bf16 v18, v105, s101, v18
    v_dot2_f32_bf16 v14, v105, v105, v14
    v_dot2_f32_bf16 v18, v106, s101, v18
    v_dot2_f32_bf16 v14, v106, v106, v14
    v_dot2_f32_bf16 v18, v107, s101, v18
    v_dot2_f32_bf16 v14, v107, v107, v14
    v_dot2_f32_bf16 v18, v108, s101, v18
    v_dot2_f32_bf16 v14, v108, v108, v14
    v_dot2_f32_bf16 v18, v109, s101, v18
    v_dot2_f32_bf16 v14, v109, v109, v14
    v_dot2_f32_bf16 v18, v110, s101, v18
    v_dot2_f32_bf16 v14, v110, v110, v14
    v_dot2_f32_bf16 v18, v111, s101, v18
    v_dot2_f32_bf16 v14, v111, v111, v14
    v_lshlrev_b32 v112, 16, v104
    v_and_b32 v113, 0xffff0000, v104
    v_lshlrev_b32 v114, 16, v105
    v_and_b32 v115, 0xffff0000, v105
    v_lshlrev_b32 v116, 16, v106
    v_and_b32 v117, 0xffff0000, v106
    v_lshlrev_b32 v118, 16, v107
    v_and_b32 v119, 0xffff0000, v107
    v_lshlrev_b32 v120, 16, v108
    v_and_b32 v121, 0xffff0000, v108
    v_lshlrev_b32 v122, 16, v109
    v_and_b32 v123, 0xffff0000, v109
    v_lshlrev_b32 v124, 16, v110
    v_and_b32 v125, 0xffff0000, v110
    v_lshlrev_b32 v126, 16, v111
    v_and_b32 v127, 0xffff0000, v111
    v_add_f32_dpp v18, v18, v18 quad_perm:[1,0,3,2] row_mask:0xf bank_mask:0xf
    v_add_f32_dpp v14, v14, v14 quad_perm:[1,0,3,2] row_mask:0xf bank_mask:0xf
    s_nop 0
    v_add_f32_dpp v18, v18, v18 quad_perm:[2,3,0,1] row_mask:0xf bank_mask:0xf
    v_add_f32_dpp v14, v14, v14 quad_perm:[2,3,0,1] row_mask:0xf bank_mask:0xf
    s_nop 0
    v_add_f32_dpp v18, v18, v18 row_ror:4 row_mask:0xf bank_mask:0xf
    v_add_f32_dpp v14, v14, v14 row_ror:4 row_mask:0xf bank_mask:0xf
    s_nop 0
    v_add_f32_dpp v18, v18, v18 row_ror:8 row_mask:0xf bank_mask:0xf
    v_add_f32_dpp v14, v14, v14 row_ror:8 row_mask:0xf bank_mask:0xf
    v_mov_b32 v20, v18
    v_mov_b32 v22, v14
    s_nop 0
    v_permlane16_swap_b32 v18, v20
    v_permlane16_swap_b32 v14, v22
    v_add_f32 v18, v18, v20
    v_add_f32 v14, v14, v22
    v_mul_f32 v18, 0x3b000000, v18
    v_mul_f32 v32, v18, v18
    v_fma_f32 v32, v14, v33, -v32
    v_max_f32 v32, 0, v32
    v_cvt_pk_bf16_f32 v12, v18, v18
    v_and_b32 v12, 0xffff0000, v12
    v_cvt_pk_bf16_f32 v32, v32, v32
    v_and_b32 v32, 0xffff0000, v32
    v_mov_b32 v13, v12
    v_add_f32 v32, 0x3727c5ac, v32
    v_cvt_pk_bf16_f32 v32, v32, v32
    v_and_b32 v32, 0xffff0000, v32
    v_sqrt_f32 v32, v32
    s_nop 0
    v_cvt_pk_bf16_f32 v32, v32, v32
    v_and_b32 v32, 0xffff0000, v32
    v_rcp_f32 v10, v32
    s_nop 0
    v_mov_b32 v11, v10
    v_pk_add_f32 v[112:113], v[112:113], v[12:13] neg_lo:[0,1] neg_hi:[0,1]
    v_pk_add_f32 v[114:115], v[114:115], v[12:13] neg_lo:[0,1] neg_hi:[0,1]
    v_pk_add_f32 v[116:117], v[116:117], v[12:13] neg_lo:[0,1] neg_hi:[0,1]
    v_pk_add_f32 v[118:119], v[118:119], v[12:13] neg_lo:[0,1] neg_hi:[0,1]
    v_pk_add_f32 v[120:121], v[120:121], v[12:13] neg_lo:[0,1] neg_hi:[0,1]
    v_pk_add_f32 v[122:123], v[122:123], v[12:13] neg_lo:[0,1] neg_hi:[0,1]
    v_pk_add_f32 v[124:125], v[124:125], v[12:13] neg_lo:[0,1] neg_hi:[0,1]
    v_pk_add_f32 v[126:127], v[126:127], v[12:13] neg_lo:[0,1] neg_hi:[0,1]
    v_cvt_pk_bf16_f32 v113, v112, v113
    v_cvt_pk_bf16_f32 v115, v114, v115
    v_cvt_pk_bf16_f32 v117, v116, v117
    v_cvt_pk_bf16_f32 v119, v118, v119
    v_cvt_pk_bf16_f32 v121, v120, v121
    v_cvt_pk_bf16_f32 v123, v122, v123
    v_cvt_pk_bf16_f32 v125, v124, v125
    v_cvt_pk_bf16_f32 v127, v126, v127
    v_lshlrev_b32 v112, 16, v113
    v_and_b32 v113, 0xffff0000, v113
    v_lshlrev_b32 v114, 16, v115
    v_and_b32 v115, 0xffff0000, v115
    v_lshlrev_b32 v116, 16, v117
    v_and_b32 v117, 0xffff0000, v117
    v_lshlrev_b32 v118, 16, v119
    v_and_b32 v119, 0xffff0000, v119
    v_lshlrev_b32 v120, 16, v121
    v_and_b32 v121, 0xffff0000, v121
    v_lshlrev_b32 v122, 16, v123
    v_and_b32 v123, 0xffff0000, v123
    v_lshlrev_b32 v124, 16, v125
    v_and_b32 v125, 0xffff0000, v125
    v_lshlrev_b32 v126, 16, v127
    v_and_b32 v127, 0xffff0000, v127
    v_pk_mul_f32 v[112:113], v[112:113], v[10:11]
    v_pk_mul_f32 v[114:115], v[114:115], v[10:11]
    v_pk_mul_f32 v[116:117], v[116:117], v[10:11]
    v_pk_mul_f32 v[118:119], v[118:119], v[10:11]
    v_pk_mul_f32 v[120:121], v[120:121], v[10:11]
    v_pk_mul_f32 v[122:123], v[122:123], v[10:11]
    v_pk_mul_f32 v[124:125], v[124:125], v[10:11]
    v_pk_mul_f32 v[126:127], v[126:127], v[10:11]
    v_cvt_pk_bf16_f32 v128, v112, v113
    v_cvt_pk_bf16_f32 v129, v114, v115
    v_cvt_pk_bf16_f32 v130, v116, v117
    v_cvt_pk_bf16_f32 v131, v118, v119
    v_cvt_pk_bf16_f32 v132, v120, v121
    v_cvt_pk_bf16_f32 v133, v122, v123
    v_cvt_pk_bf16_f32 v134, v124, v125
    v_cvt_pk_bf16_f32 v135, v126, v127
    ds_write_b128 v17, v[128:131] offset:8192
    ds_write_b128 v17, v[132:135] offset:8704
    ds_read_u16 v24, v15 offset:8192
    v_dot2_f32_bf16 v14, v128, v136, 0
    v_dot2_f32_bf16 v14, v129, v137, v14
    v_dot2_f32_bf16 v14, v130, v138, v14
    v_dot2_f32_bf16 v14, v131, v139, v14
    v_dot2_f32_bf16 v14, v132, v140, v14
    v_dot2_f32_bf16 v14, v133, v141, v14
    v_dot2_f32_bf16 v14, v134, v142, v14
    v_dot2_f32_bf16 v14, v135, v143, v14
    s_nop 2
    v_add_f32_dpp v14, v14, v14 quad_perm:[1,0,3,2] row_mask:0xf bank_mask:0xf
    s_nop 1
    v_add_f32_dpp v14, v14, v14 quad_perm:[2,3,0,1] row_mask:0xf bank_mask:0xf
    s_nop 1
    v_add_f32_dpp v14, v14, v14 row_ror:4 row_mask:0xf bank_mask:0xf
    s_nop 1
    v_add_f32_dpp v14, v14, v14 row_ror:8 row_mask:0xf bank_mask:0xf
    v_mov_b32 v20, v14
    s_nop 1
    v_permlane16_swap_b32 v14, v20
    v_add_f32 v14, v14, v20
    v_cvt_pk_bf16_f32 v14, v14, v14
    v_and_b32 v14, 0xffff0000, v14
    v_mul_f32 v20, 0xbfb8aa3b, v14
    v_exp_f32 v20, v20
    s_nop 0
    v_add_f32 v20, 1.0, v20
    v_rcp_f32 v20, v20
    s_nop 0
    v_cvt_pk_bf16_f32 v20, v20, v20
    v_and_b32 v20, 0xffff0000, v20
    s_nop 0
    v_readlane_b32 s100, v20, 0
    v_readlane_b32 s101, v20, 32
    v_cmp_eq_u32 vcc, 1, v16
    v_mov_b32 v14, s100
    v_mov_b32 v20, s101
    v_cndmask_b32 v14, v14, v20, vcc
    s_waitcnt lgkmcnt(0)
    v_lshlrev_b32 v24, 16, v24
    v_lshlrev_b32 v25, 16, v25
    v_add_f32 v24, v24, v25
    s_mov_b32 s77, 400000
    buffer_load_dwordx4 v[48:51], v21, s[44:47], 0 offen offset:0 sc1
    buffer_load_dwordx4 v[52:55], v21, s[44:47], 0 offen offset:1024 sc1
    buffer_load_dwordx4 v[56:59], v21, s[44:47], 0 offen offset:2048 sc1
    buffer_load_dwordx4 v[60:63], v21, s[44:47], 0 offen offset:3072 sc1
    buffer_load_dwordx4 v[64:67], v19, s[44:47], 0 offen offset:0 sc1
    buffer_load_dwordx4 v[68:71], v19, s[44:47], 0 offen offset:1024 sc1
L_yp:
    buffer_load_dwordx4 v[80:83], v21, s[44:47], 0 offen offset:0 sc1
    buffer_load_dwordx4 v[84:87], v21, s[44:47], 0 offen offset:1024 sc1
    buffer_load_dwordx4 v[88:91], v21, s[44:47], 0 offen offset:2048 sc1
    buffer_load_dwordx4 v[92:95], v21, s[44:47], 0 offen offset:3072 sc1
    buffer_load_dwordx4 v[96:99], v19, s[44:47], 0 offen offset:0 sc1
    buffer_load_dwordx4 v[100:103], v19, s[44:47], 0 offen offset:1024 sc1
    s_waitcnt vmcnt(11)
    v_xor_b32 v20, s48, v48
    v_bitop3_b32 v20, v20, v49, s49 bitop3:0xf6
    v_xor_b32 v18, s50, v50
    v_bitop3_b32 v18, v18, v51, s51 bitop3:0xf6
    s_waitcnt vmcnt(10)
    v_bitop3_b32 v20, v20, v52, s48 bitop3:0xf6
    v_bitop3_b32 v20, v20, v53, s49 bitop3:0xf6
    v_bitop3_b32 v18, v18, v54, s50 bitop3:0xf6
    v_bitop3_b32 v18, v18, v55, s51 bitop3:0xf6
    v_pk_add_f32 v[28:29], v[48:49], v[52:53]
    v_pk_add_f32 v[30:31], v[50:51], v[54:55]
    s_waitcnt vmcnt(9)
    v_bitop3_b32 v20, v20, v56, s48 bitop3:0xf6
    v_bitop3_b32 v20, v20, v57, s49 bitop3:0xf6
    v_bitop3_b32 v18, v18, v58, s50 bitop3:0xf6
    v_bitop3_b32 v18, v18, v59, s51 bitop3:0xf6
    v_pk_add_f32 v[28:29], v[28:29], v[56:57]
    v_pk_add_f32 v[30:31], v[30:31], v[58:59]
    s_waitcnt vmcnt(8)
    v_bitop3_b32 v20, v20, v60, s48 bitop3:0xf6
    v_bitop3_b32 v20, v20, v61, s49 bitop3:0xf6
    v_bitop3_b32 v18, v18, v62, s50 bitop3:0xf6
    v_bitop3_b32 v18, v18, v63, s51 bitop3:0xf6
    v_pk_add_f32 v[28:29], v[28:29], v[60:61]
    v_pk_add_f32 v[30:31], v[30:31], v[62:63]
    s_waitcnt vmcnt(7)
    v_bitop3_b32 v20, v20, v64, s48 bitop3:0xf6
    v_bitop3_b32 v20, v20, v65, s49 bitop3:0xf6
    v_bitop3_b32 v18, v18, v66, s50 bitop3:0xf6
    v_bitop3_b32 v18, v18, v67, s51 bitop3:0xf6
    v_pk_add_f32 v[28:29], v[28:29], v[64:65]
    v_pk_add_f32 v[30:31], v[30:31], v[66:67]
    s_waitcnt vmcnt(6)
    s_mov_b64 exec, 0xffffff
    v_bitop3_b32 v20, v20, v68, s48 bitop3:0xf6
    v_bitop3_b32 v20, v20, v69, s49 bitop3:0xf6
    v_bitop3_b32 v18, v18, v70, s50 bitop3:0xf6
    v_bitop3_b32 v18, v18, v71, s51 bitop3:0xf6
    s_mov_b64 exec, -1
    v_pk_add_f32 v[28:29], v[28:29], v[68:69]
    v_pk_add_f32 v[30:31], v[30:31], v[70:71]
    v_bitop3_b32 v20, v20, v18, v4 bitop3:0xa8
    v_permlane16_swap_b32 v28, v29
    v_permlane16_swap_b32 v30, v31
    v_add_f32 v28, v28, v29
    v_add_f32 v30, v30, v31
    v_cmp_ne_u32 vcc, 0, v20
    s_cbranch_vccz L_yp_ok
    buffer_load_dwordx4 v[48:51], v21, s[44:47], 0 offen offset:0 sc1
    buffer_load_dwordx4 v[52:55], v21, s[44:47], 0 offen offset:1024 sc1
    buffer_load_dwordx4 v[56:59], v21, s[44:47], 0 offen offset:2048 sc1
    buffer_load_dwordx4 v[60:63], v21, s[44:47], 0 offen offset:3072 sc1
    buffer_load_dwordx4 v[64:67], v19, s[44:47], 0 offen offset:0 sc1
    buffer_load_dwordx4 v[68:71], v19, s[44:47], 0 offen offset:1024 sc1
    s_waitcnt vmcnt(11)
    v_xor_b32 v20, s48, v80
    v_bitop3_b32 v20, v20, v81, s49 bitop3:0xf6
    v_xor_b32 v18, s50, v82
    v_bitop3_b32 v18, v18, v83, s51 bitop3:0xf6
    s_waitcnt vmcnt(10)
    v_bitop3_b32 v20, v20, v84, s48 bitop3:0xf6
    v_bitop3_b32 v20, v20, v85, s49 bitop3:0xf6
    v_bitop3_b32 v18, v18, v86, s50 bitop3:0xf6
    v_bitop3_b32 v18, v18, v87, s51 bitop3:0xf6
    v_pk_add_f32 v[28:29], v[80:81], v[84:85]
    v_pk_add_f32 v[30:31], v[82:83], v[86:87]
    s_waitcnt vmcnt(9)
    v_bitop3_b32 v20, v20, v88, s48 bitop3:0xf6
    v_bitop3_b32 v20, v20, v89, s49 bitop3:0xf6
    v_bitop3_b32 v18, v18, v90, s50 bitop3:0xf6
    v_bitop3_b32 v18, v18, v91, s51 bitop3:0xf6
    v_pk_add_f32 v[28:29], v[28:29], v[88:89]
    v_pk_add_f32 v[30:31], v[30:31], v[90:91]
    s_waitcnt vmcnt(8)
    v_bitop3_b32 v20, v20, v92, s48 bitop3:0xf6
    v_bitop3_b32 v20, v20, v93, s49 bitop3:0xf6
    v_bitop3_b32 v18, v18, v94, s50 bitop3:0xf6
    v_bitop3_b32 v18, v18, v95, s51 bitop3:0xf6
    v_pk_add_f32 v[28:29], v[28:29], v[92:93]
    v_pk_add_f32 v[30:31], v[30:31], v[94:95]
    s_waitcnt vmcnt(7)
    v_bitop3_b32 v20, v20, v96, s48 bitop3:0xf6
    v_bitop3_b32 v20, v20, v97, s49 bitop3:0xf6
    v_bitop3_b32 v18, v18, v98, s50 bitop3:0xf6
    v_bitop3_b32 v18, v18, v99, s51 bitop3:0xf6
    v_pk_add_f32 v[28:29], v[28:29], v[96:97]
    v_pk_add_f32 v[30:31], v[30:31], v[98:99]
    s_waitcnt vmcnt(6)
    s_mov_b64 exec, 0xffffff
    v_bitop3_b32 v20, v20, v100, s48 bitop3:0xf6
    v_bitop3_b32 v20, v20, v101, s49 bitop3:0xf6
    v_bitop3_b32 v18, v18, v102, s50 bitop3:0xf6
    v_bitop3_b32 v18, v18, v103, s51 bitop3:0xf6
    s_mov_b64 exec, -1
    v_pk_add_f32 v[28:29], v[28:29], v[100:101]
    v_pk_add_f32 v[30:31], v[30:31], v[102:103]
    v_bitop3_b32 v20, v20, v18, v4 bitop3:0xa8
    v_permlane16_swap_b32 v28, v29
    v_permlane16_swap_b32 v30, v31
    v_add_f32 v28, v28, v29
    v_add_f32 v30, v30, v31
    v_cmp_ne_u32 vcc, 0, v20
    s_cbranch_vccz L_yp_ok
    s_sub_u32 s77, s77, 1
    s_cbranch_scc1 L_end
    s_branch L_yp
L_yp_ok:
    s_nop 1
    v_permlane32_swap_b32 v28, v30
    v_add_f32 v28, v28, v30
    s_nop 1
    v_add_f32_dpp v28, v28, v28 row_ror:8 row_mask:0xf bank_mask:0xf
    v_fma_f32 v28, v28, v14, v24
    v_cvt_pk_bf16_f32 v28, v28, v28
    s_mov_b32 exec_lo, 0x00ff00ff
    s_mov_b32 exec_hi, 0x00ff00ff
    global_store_short v15, v28, s[24:25]
    s_mov_b64 exec, -1
L_exit8:
    s_nop 0
    s_waitcnt lgkmcnt(0)
    s_endpgm
L_codeend:
.section .rodata,"a"
.p2align 6
.amdhsa_kernel sequential_preLN__sliding_block_cached__moe_arch_mod__decode_kernel
  .amdhsa_next_free_vgpr 168
  .amdhsa_next_free_sgpr 102
  .amdhsa_accum_offset 168
  .amdhsa_group_segment_fixed_size 0
  .amdhsa_kernarg_size 104
  .amdhsa_user_sgpr_count 2
  .amdhsa_user_sgpr_kernarg_segment_ptr 1
  .amdhsa_system_sgpr_workgroup_id_x 1
  .amdhsa_float_denorm_mode_32 3
.end_amdhsa_kernel
```
